```python
import torch

def _softmax(x, axis=-1):
    return torch.softmax(x, dim=axis)
def _gelu(x):
    return torch.nn.functional.gelu(x, approximate="tanh")
def _silu(x):
    return torch.nn.functional.silu(x)
def _sigmoid(x):
    return torch.sigmoid(x)
def _layernorm(x, axis=-1, eps=1e-5):
    m = x.mean(dim=axis, keepdim=True)
    v = x.var(dim=axis, keepdim=True, unbiased=False)
    return (x - m) / torch.sqrt(v + eps)
def _scatter_add(tgt, idx, src, axis=0):
    return tgt.clone().index_add_(axis, idx, src)
def _segment_sum(src, seg, n):
    out = torch.zeros((n,) + src.shape[1:], dtype=src.dtype)
    return out.index_add_(0, seg, src)
def _pad(x, pw):
    flat = tuple(v for pair in reversed(pw) for v in pair)
    return torch.nn.functional.pad(x, flat)

kernel_name = 'parallel_sum__ssm_conv_s5__mixer_channel_mlp__prompt'

def setup_inputs():

    _w = (lambda a: (lambda t: t.to(torch.bfloat16) if t.is_floating_point() else t)(torch.as_tensor(a)))
    def _A_setup():
        B, S, D = 1, 2048, 512
        P = D
        Lambda_re = -0.5 * (lambda _x: torch.exp(torch.as_tensor(_x)))((lambda *s: torch.randn(*s, dtype=torch.bfloat16) * 0.2)(P))
        Lambda_im = (lambda *s: torch.randn(*s, dtype=torch.bfloat16) * 0.8)(P) * 1.0
        B_re = (lambda *s: torch.randn(*s, dtype=torch.bfloat16) * 0.2)(P, D) * (D ** -0.5)
        B_im = (lambda *s: torch.randn(*s, dtype=torch.bfloat16) * 0.2)(P, D) * (D ** -0.5)
        C_re = (lambda *s: torch.randn(*s, dtype=torch.bfloat16) * 0.2)(D, P) * (P ** -0.5)
        C_im = (lambda *s: torch.randn(*s, dtype=torch.bfloat16) * 0.2)(D, P) * (P ** -0.5)
        log_dt = (lambda *s: torch.randn(*s, dtype=torch.bfloat16) * 0.2)(P) * 0.3 - 2.0
        Dskip = (lambda *s: torch.randn(*s, dtype=torch.bfloat16) * 0.05)(D)
        return {
            "x": _w((lambda *s: torch.randn(*s, dtype=torch.bfloat16) * 0.05)(B, S, D)),
            "Lambda_re": _w(Lambda_re),
            "Lambda_im": _w(Lambda_im),
            "B_re": _w(B_re),
            "B_im": _w(B_im),
            "C_re": _w(C_re),
            "C_im": _w(C_im),
            "log_dt": _w(log_dt),
            "Dskip": _w(Dskip),
        }
    _A_in = _A_setup()

    def _B_setup():
        B, S, D, F = 1, 2048, 512, 1376
        return {
            "x": _w((lambda *s: torch.randn(*s, dtype=torch.bfloat16) * 0.05)(B, S, D)),
            "w1": _w((lambda *s: torch.randn(*s, dtype=torch.bfloat16) * 1.6)(D, F) * (D ** -0.5)),
            "b1": _w((lambda *s: torch.randn(*s, dtype=torch.bfloat16) * 0.8)(F)),
            "w2": _w((lambda *s: torch.randn(*s, dtype=torch.bfloat16) * 0.05)(F, D) * (F ** -0.5)),
            "b2": _w((lambda *s: torch.randn(*s, dtype=torch.bfloat16) * 0.05)(D)),
        }
    _B_in = _B_setup()

    return {
        "A_x": _A_in["x"],
        "A_Lambda_re": _A_in["Lambda_re"],
        "A_Lambda_im": _A_in["Lambda_im"],
        "A_B_re": _A_in["B_re"],
        "A_B_im": _A_in["B_im"],
        "A_C_re": _A_in["C_re"],
        "A_C_im": _A_in["C_im"],
        "A_log_dt": _A_in["log_dt"],
        "A_Dskip": _A_in["Dskip"],
        "B_x": _B_in["x"],
        "B_w1": _B_in["w1"],
        "B_b1": _B_in["b1"],
        "B_w2": _B_in["w2"],
        "B_b2": _B_in["b2"],
    }

def reference(A_x, A_Lambda_re, A_Lambda_im, A_B_re, A_B_im, A_C_re, A_C_im, A_log_dt, A_Dskip, B_x, B_w1, B_b1, B_w2, B_b2):
    def _A_ref(x, Lambda_re, Lambda_im, B_re, B_im, C_re, C_im, log_dt, Dskip):
        Bsz, L, H = x.shape
        Lam = Lambda_re + 1j * Lambda_im
        Bmat = B_re + 1j * B_im
        Cmat = C_re + 1j * C_im
        dt = torch.exp(log_dt)
        Lam_bar = torch.exp(dt * Lam)
        B_bar = ((Lam_bar - 1.0) / Lam)[:, None] * Bmat
        Bu = torch.einsum("bld,pd->blp", x + 0j, B_bar)
        h = torch.zeros_like(Bu[:, 0, :])
        hs = []
        for t in range(L):
            h = Lam_bar[None, :] * h + Bu[:, t, :]
            hs.append(h)
        hseq = torch.stack(hs, 1)
        y = 2.0 * torch.einsum("blp,dp->bld", hseq, Cmat).real + x * Dskip[None, None, :]
        return y

    def _B_ref(x, w1, b1, w2, b2):
        y = _layernorm(x, axis=-1)
        h = _gelu(torch.einsum("bsd,df->bsf", y, w1) + b1)
        return torch.einsum("bsf,fd->bsd", h, w2) + b2

    x = A_x
    xn = _layernorm(x, axis=-1)
    return x + _A_ref(xn, A_Lambda_re, A_Lambda_im, A_B_re, A_B_im, A_C_re, A_C_im, A_log_dt, A_Dskip) + _B_ref(xn, B_w1, B_b1, B_w2, B_b2)
```

```asm
; @launch grid=(256,1,1) block=(256,1,1) lds=163840
.amdgcn_target "amdgcn-amd-amdhsa--gfx950"
.text
.globl parallel_sum__ssm_conv_s5__mixer_channel_mlp__prompt_kernel
.p2align 12
.type parallel_sum__ssm_conv_s5__mixer_channel_mlp__prompt_kernel,@function
parallel_sum__ssm_conv_s5__mixer_channel_mlp__prompt_kernel:
    s_cmp_ge_u32 s2, 256
    s_cbranch_scc1 L_end
    s_load_dwordx16 s[16:31], s[0:1], 0
    s_load_dwordx16 s[32:47], s[0:1], 64
    s_load_dwordx2 s[48:49], s[0:1], 128
    s_getpc_b64 s[14:15]
L_pc:
    v_and_b32 v255, 63, v0
    v_lshrrev_b32 v1, 6, v0
    v_lshlrev_b32 v254, 4, v255
    v_readfirstlane_b32 s4, v1
    v_lshrrev_b32 v2, 5, v0
    s_and_b32 s3, s2, 248
    s_lshl_b32 s3, s3, 7
    v_lshl_add_u32 v2, v2, 7, s3
    v_min_u32 v2, L_end-L_pc, v2
    global_load_dword v248, v2, s[14:15]
    s_and_b32 s7, s2, 1
    s_lshr_b32 s9, s2, 6
    s_bfe_u32 s8, s2, 0x30003
    s_bfe_u32 s3, s2, 0x20001
    s_lshl2_add_u32 s5, s3, s9
    s_lshl3_add_u32 s6, s7, s8
    s_lshl2_add_u32 s11, s2, s4
    s_add_u32 s86, s9, s8
    s_mov_b32 s50, 0x76532410
    s_mov_b32 s87, 0x76435201
    s_bitcmp1_b32 s86, 0
    s_cselect_b32 s50, 0x75463120, s50
    s_cselect_b32 s87, 0x65742031, s87
    s_bitcmp1_b32 s86, 1
    s_cselect_b32 s50, s87, s50
    s_lshl1_add_u32 s87, s7, s3
    s_and_b32 s87, s87, 3
    s_mul_i32 s87, s87, 0x22222222
    s_xor_b32 s50, s50, s87
    v_lshrrev_b32 v250, 5, v255
    v_and_b32 v251, 31, v255
    v_lshrrev_b32 v252, 4, v255
    v_and_b32 v253, 15, v255
    s_lshr_b32 s12, s4, 1
    s_and_b32 s13, s4, 1
    v_and_b32 v1, 7, v255
    v_lshrrev_b32 v3, 3, v255
    v_xor_b32 v4, v1, v252
    v_lshlrev_b32 v4, 4, v4
    s_lshl1_add_u32 s86, s5, s12
    s_lshl_b32 s86, s86, 6
    s_add_u32 s86, s86, s13
    s_lshl_b32 s86, s86, 10
    v_lshl_add_u32 v5, v3, 12, v4
    v_add_u32 v168, s86, v5
    v_xor_b32 v169, 64, v168
    v_add_u32 v169, 31744, v169
    s_lshl1_add_u32 s85, s6, s12
    s_lshl_b32 s85, s85, 14
    v_lshl_add_u32 v5, v3, 10, v4
    v_add_u32 v170, s85, v5
    v_xor_b32 v171, 64, v170
    v_add_u32 v171, 7168, v171
    s_lshr_b32 s86, s6, 2
    s_mul_i32 s86, s86, 22
    s_and_b32 s87, s6, 3
    s_cmp_eq_u32 s87, 3
    s_cselect_b32 s84, 8, 0
    s_mul_i32 s87, s87, 6
    s_add_u32 s14, s86, s87
    s_lshl_b32 s78, s14, 5
    s_mul_i32 s86, s4, 44032
    s_add_u32 s78, s78, s86
    s_movk_i32 s86, 5462
    s_movk_i32 s87, 2752
    v_add_u32 v6, 0, v255
    v_mul_u32_u24 v7, s86, v6
    v_lshrrev_b32 v7, 16, v7
    v_mul_u32_u24 v8, 12, v7
    v_sub_u32 v6, v6, v8
    v_lshrrev_b32 v8, 3, v7
    v_lshlrev_b32 v8, 1, v8
    v_xor_b32 v6, v6, v8
    v_mul_u32_u24 v7, s87, v7
    v_and_b32_e64 v8, s84, v6
    v_lshl_add_u32 v7, v8, 27, v7
    v_lshl_add_u32 v6, v6, 4, v7
    v_add_u32_e64 v172, s78, v6
    s_sub_u32 s78, s78, 1024
    v_add_u32 v6, 64, v255
    v_mul_u32_u24 v7, s86, v6
    v_lshrrev_b32 v7, 16, v7
    v_mul_u32_u24 v8, 12, v7
    v_sub_u32 v6, v6, v8
    v_lshrrev_b32 v8, 3, v7
    v_lshlrev_b32 v8, 1, v8
    v_xor_b32 v6, v6, v8
    v_mul_u32_u24 v7, s87, v7
    v_and_b32 v8, s84, v6
    v_lshl_add_u32 v7, v8, 27, v7
    v_lshl_add_u32 v6, v6, 4, v7
    v_add_u32_e64 v173, s78, v6
    s_sub_u32 s78, s78, 1024
    v_add_u32 v6, 128, v255
    v_mul_u32_u24_e64 v7, s86, v6
    v_lshrrev_b32 v7, 16, v7
    v_mul_u32_u24 v8, 12, v7
    v_sub_u32 v6, v6, v8
    v_lshrrev_b32 v8, 3, v7
    v_lshlrev_b32 v8, 1, v8
    v_xor_b32 v6, v6, v8
    v_mul_u32_u24 v7, s87, v7
    v_and_b32 v8, s84, v6
    v_lshl_add_u32 v7, v8, 27, v7
    v_lshl_add_u32 v6, v6, 4, v7
    v_add_u32 v174, s78, v6
    s_mul_i32 s76, s4, 9216
    s_lshl_b32 s86, s6, 6
    v_lshl_add_u32 v9, v251, 1, s86
    v_mov_b32_e64 v10, 0
    s_mov_b32 s54, 0x200000
    s_mov_b32 s55, 0x20000
    s_mov_b32 s62, 0x80000
    s_mov_b32 s63, 0x20000
    s_mov_b32 s66, 1409024
    s_mov_b32 s67, 0x20000
    s_mov_b32 s58, 0x1200000
    s_mov_b32 s59, 0x20000
    s_movk_i32 s74, 2752
    s_mov_b32 s75, 0x20000
    s_add_u32 s86, s14, s13
    s_lshl_b32 s86, s86, 5
    v_lshl_add_u32 v15, v252, 3, s86
    s_lshl_b32 s87, s8, 7
    v_lshl_add_u32 v16, v253, 3, s87
    s_lshl1_add_u32 s86, s5, s7
    s_and_b32 s87, s6, 1
    s_lshl1_add_u32 s86, s86, s87
    s_lshl2_add_u32 s86, s86, s4
    s_bfe_u32 s87, s6, 0x20001
    s_lshl3_add_u32 s86, s86, s87
    s_lshl_b32 s80, s86, 10
    v_lshlrev_b32_e64 v177, 12, v250
    v_lshl_add_u32 v177, v251, 4, v177
    s_bfe_u32 s78, s50, 0x30000
    s_add_u32 m0, s76, 4096
    s_lshl_b32 s77, s78, 7
    v_lshrrev_b32 v1, 1, v253
    v_xor_b32 v1, v1, v252
    v_lshlrev_b32 v1, 4, v1
    v_lshl_add_u32 v1, v253, 7, v1
    s_lshl_b32 s86, s12, 6
    v_xor_b32 v1, s86, v1
    v_xor_b32_e64 v2, 64, v1
    s_mul_i32 s86, s12, 18432
    s_mul_i32 s87, s13, 18432
    s_add_u32 s87, s87, 4096
    v_add_u32 v156, s86, v1
    v_add_u32 v160, s87, v1
    v_add_u32 v157, 73728, v156
    v_add_u32 v161, 73728, v160
    v_add_u32 v158, s86, v2
    v_add_u32 v162, s87, v2
    v_add_u32 v159, 73728, v158
    v_add_u32 v163, 73728, v162
    v_bfe_u32 v1, v255, 2, 2
    v_bfe_u32 v2, v255, 4, 1
    s_cmp_eq_u32 s13, 0
L_m_pre:
    s_waitcnt lgkmcnt(0)
L_m_karg:
    s_cselect_b64 s[60:61], s[22:23], s[24:25]
    s_mov_b64 s[52:53], s[16:17]
    s_mov_b64 s[56:57], s[48:49]
    global_load_ushort v11, v9, s[18:19]
    global_load_ushort v12, v9, s[20:21]
    global_load_ushort v13, v9, s[30:31]
    buffer_load_dword v14, v10, s[56:59], 0 offen sc1
    s_mov_b64 s[64:65], s[36:37]
    buffer_load_dwordx4 v[188:191], v177, s[52:55], s80 offen offset:0
    buffer_load_dwordx4 v[192:195], v177, s[52:55], s80 offen offset:512
    s_mov_b64 s[72:73], s[38:39]
    buffer_load_dwordx2 v[180:181], v15, s[72:75], 0 offen offset:0
    buffer_load_dwordx2 v[182:183], v15, s[72:75], 0 offen offset:64
    buffer_load_dwordx2 v[184:185], v15, s[72:75], 0 offen offset:128
    global_load_dwordx2 a[248:249], v16, s[32:33]
    global_load_dwordx2 a[250:251], v16, s[42:43]
    s_mov_b32 s74, 0x80000
    s_barrier
L_m_sm:
    buffer_load_dwordx4 v170, s[60:63], s77 offen offset:0 lds
    buffer_load_dwordx4 v171, s[60:63], s77 offen offset:1024 lds
    s_mov_b64 s[68:69], s[40:41]
    s_add_u32 m0, s76, 6144
    s_mul_i32 s78, s78, 176128
    buffer_load_dwordx4 v172, s[64:67], s78 offen offset:0 lds
    s_lshl_b32 s80, s4, 13
    v_lshl_add_u32 v3, v2, 3, v1
    v_mul_u32_u24 v3, 192, v3
    v_xor_b32_e64 v4, s13, v2
    v_lshl_add_u32 v3, v4, 5, v3
    v_and_b32 v4, 3, v255
    v_lshl_add_u32 v3, v4, 3, v3
    s_movk_i32 s87, 9216
    v_mad_u32_u24 v3, v250, s87, v3
    s_add_u32 s87, s86, 6144
    s_sub_u32 s86, 24576, s86
    v_add_u32 v164, s87, v3
    v_add_u32 v166, s86, v3
    v_add_u32 v165, 73728, v164
    v_add_u32 v167, 73728, v166
    v_and_b32 v5, 7, v255
    v_lshlrev_b32 v6, 2, v2
    v_xor_b32 v5, v5, v6
    v_lshlrev_b32 v5, 4, v5
    v_lshrrev_b32_e64 v6, 3, v255
    v_lshl_add_u32 v175, v6, 10, v5
    v_add_u32 v176, 7168, v175
    buffer_load_dwordx4 v173, s[64:67], s78 offen offset:1024 lds
    v_lshl_add_u32 v5, v250, 3, v1
    v_lshlrev_b32 v5, 7, v5
    v_lshrrev_b32 v6, 1, v1
    v_lshl_add_u32 v5, v6, 6, v5
    v_lshl_add_u32 v5, v2, 5, v5
    v_lshl_add_u32 v178, v4, 3, v5
    v_mov_b32 v152, 0x3f803f80
    v_cmp_eq_u32 s[88:89], 0, v253
    v_cmp_eq_u32 s[90:91], 1, v253
    v_cmp_eq_u32 s[92:93], 2, v253
    v_cmp_eq_u32 s[94:95], 3, v253
    v_cmp_eq_u32_e64 vcc, 4, v253
    v_cndmask_b32 v80, 0, v152, s[88:89]
    v_cndmask_b32 v84, 0, v152, s[90:91]
    v_cndmask_b32 v88, 0, v152, s[92:93]
    v_cndmask_b32 v92, 0, v152, s[94:95]
    v_cndmask_b32 v96, 0, v152, vcc
    v_mov_b32 v81, v80
    v_mov_b32 v85, v84
    v_mov_b32 v89, v88
    v_mov_b32 v93, v92
    v_mov_b32 v97, v96
    v_mov_b64 v[82:83], v[80:81]
    v_mov_b64 v[86:87], v[84:85]
    buffer_load_dwordx4 v174, s[64:67], s78 offen offset:2048 lds
    v_mov_b64 v[90:91], v[88:89]
    v_mov_b64 v[94:95], v[92:93]
    v_mov_b64 v[98:99], v[96:97]
    s_lshl2_add_u32 s87, s7, s4
    s_lshl_b32 s79, s8, 9
    s_add_u32 s79, s79, s87
    s_lshl_b32 s79, s79, 7
    s_lshr_b32 s86, s87, 1
    s_mul_i32 s86, s86, 22
    s_add_u32 s86, s86, s13
    s_lshl_b32 s82, s86, 7
    s_add_u32 s82, s82, s8
    s_lshl_b32 s82, s82, 7
    v_lshlrev_b32 v245, 10, v255
    v_lshrrev_b32 v186, 2, v255
    v_mad_u32_u24 v186, v4, 3, v186
    s_lshl2_add_u32 s84, s9, s3
    s_lshl_b32 s87, s84, 10
    v_lshl_add_u32 v246, v186, 15, s87
    s_lshl_b32 s84, s84, 2
    s_mov_b32 s70, 1409024
    s_mov_b32 s71, 0x20000
    s_mul_i32 s81, s12, 36864
    s_lshl_b32 s86, s13, 11
    s_add_u32 s81, s81, s86
    s_add_u32 m0, s76, 0
    s_nop 0
    buffer_load_dwordx4 v168, s[52:55], s77 offen offset:0 lds
    s_add_u32 s81, s81, 32768
    s_lshl_b32 s86, s13, 6
    s_add_u32 s86, s86, 147456
    s_movk_i32 s87, 272
    v_lshl_add_u32 v228, v252, 4, s86
    v_lshl_add_u32 v230, v253, 2, s86
    v_mad_u32_u24 v229, v253, s87, v228
    v_min_u32_e64 v186, 1, v252
    v_lshl_add_u32 v186, v186, 4, v252
    v_mad_u32_u24 v231, v186, s87, v230
    s_mul_i32 s86, s4, 320
    s_add_u32 s86, s86, 154256
    v_lshl_add_u32 v247, v252, 4, s86
    v_lshl_add_u32 v234, v253, 6, v247
    s_nop 0
    s_xor_b32 s86, s4, 2
    s_mul_i32 s86, s86, 320
    s_add_u32 s86, s86, 154256
    v_lshl_add_u32 v235, v252, 4, s86
    v_lshl_add_u32 v232, v253, 2, s86
    s_mul_i32 s86, s13, 320
    s_add_u32 s86, s86, 154256
    v_lshl_add_u32 v233, v253, 2, s86
    s_sub_u32 s86, s5, 1
    buffer_load_dwordx4 v169, s[52:55], s77 offen offset:1024 lds
    v_sub_u32 v186, s86, v252
    v_lshlrev_b32 v187, 4, v253
    v_subrev_u32 v240, 0, v186
    v_cmp_le_i32 s[88:89], 0, v240
    v_max_i32_e64 v240, 0, v240
    v_lshl_add_u32 v240, v240, 8, v187
    v_subrev_u32_e64 v241, 4, v186
    v_cmp_le_i32 s[90:91], 0, v241
    v_max_i32_e64 v241, 0, v241
    v_lshl_add_u32 v241, v241, 8, v187
    v_subrev_u32_e64 v242, 8, v186
    v_cmp_le_i32 s[92:93], 0, v242
    v_max_i32_e64 v242, 0, v242
    v_lshl_add_u32 v242, v242, 8, v187
    v_subrev_u32_e64 v243, 12, v186
    v_cmp_le_i32 s[94:95], 0, v243
    v_max_i32_e64 v243, 0, v243
    v_lshl_add_u32 v243, v243, 8, v187
    v_lshlrev_b32 v237, 2, v251
    s_lshl1_add_u32 s86, s5, s7
    s_lshl1_add_u32 s86, s86, s12
    s_lshl2_add_u32 s86, s86, s13
    s_lshl_b32 s86, s86, 3
    v_and_b32 v239, 1, v252
    v_lshl_add_u32 v239, v239, 2, v250
    buffer_load_dwordx4 v168, s[52:55], s77 offen offset:2048 lds
    v_lshl_add_u32 v186, v239, 2, s86
    v_lshl_add_u32 v238, v186, 10, v16
    v_lshlrev_b32 v239, 4, v239
    s_lshl_b64 s[40:41], 15, s84
    s_lshl1_add_u32 s87, s5, s7
    s_lshl3_add_u32 s31, s87, s12
    s_lshl2_add_u32 s31, s31, s13
    s_lshl_b32 s31, s31, 5
    s_add_u32 s31, s31, 0x8008
    s_lshl1_add_u32 s86, s6, s13
    s_lshl_b32 s86, s86, 12
    s_add_u32 s17, s86, 0x10000
    s_lshl_b32 s18, s5, 8
    s_add_u32 s18, s18, s17
    s_lshl1_add_u32 s87, s5, s12
    s_mul_i32 s87, s87, 311296
    s_add_u32 s20, s86, s87
    s_add_u32 s20, s20, 0x82c000
    s_add_u32 s19, s14, s13
    s_lshl_b32 s19, s19, 11
    s_add_u32 s19, s19, s87
    s_add_u32 s19, s19, 0x800000
    s_lshl4_add_u32 s21, s5, s6
    s_lshl2_add_u32 s21, s21, s4
    buffer_load_dwordx4 v169, s[52:55], s77 offen offset:3072 lds
    s_lshl_b32 s38, s21, 5
    s_add_u32 s38, s38, 0x8000
    s_lshl_b32 s21, s21, 7
    s_add_u32 s39, s6, 1
    s_and_b32 s39, s39, 3
L_m_prep:
L_m_d0:
    s_waitcnt vmcnt(16)
L_m_lam:
    v_readfirstlane_b32 s10, v14
    v_lshlrev_b32 v11, 16, v11
    v_lshlrev_b32 v12, 16, v12
    v_lshlrev_b32 v13, 16, v13
    v_mul_f32 v13, 0x3fb8aa3b, v13
    v_exp_f32_e64 v13, v13
    s_add_u32 s10, s10, 1
    v_add_u32 v179, 1, v14
    s_lshl_b32 s86, s4, 1
    v_add_u32 v1, s86, v250
    v_cvt_pk_bf16_f32 v13, v13, v13
    v_cvt_f32_u32 v2, v1
    v_lshlrev_b32 v13, 16, v13
    v_cmp_lt_u32_e64 vcc, 4, v1
    v_mul_u32_u24 v3, 272, v1
    v_mul_f32 v5, v13, v11
    v_mul_f32 v6, v13, v12
    v_lshl_add_u32 v3, v251, 2, v3
    v_mul_f32 v5, 0x3fb8aa3b, v5
    v_mul_f32_e64 v6, 0.15915494, v6
    v_add_u32 v3, 147456, v3
    v_mul_f32_e64 v20, 4.0, v2
    v_add_f32 v21, 0x42000000, v20
    v_mul_f32 v22, 0x43000000, v2
    v_max_f32 v22, 0x42800000, v22
    v_add_f32_e64 v23, -4.0, v2
    v_cndmask_b32 v22, v22, v23, vcc
    v_mul_f32 v24, v20, v5
    v_mul_f32 v28, v20, v6
    v_mul_f32 v25, v21, v5
    v_mul_f32 v29, v21, v6
    v_mul_f32 v26, v22, v5
    v_mul_f32 v30, v22, v6
    v_exp_f32 v24, v24
    v_rndne_f32 v20, v28
    v_exp_f32 v25, v25
    v_rndne_f32 v21, v29
    v_exp_f32 v26, v26
    v_rndne_f32 v22, v30
    v_sub_f32 v28, v28, v20
    v_sub_f32 v29, v29, v21
    v_sub_f32 v30, v30, v22
    v_cos_f32 v20, v28
    v_sin_f32 v28, v28
    v_cos_f32 v21, v29
    v_sin_f32 v29, v29
    v_cos_f32 v22, v30
    v_sin_f32 v30, v30
    v_mul_f32 v20, v20, v24
    v_mul_f32 v28, v28, v24
    v_mul_f32 v21, v21, v25
    v_mul_f32 v29, v29, v25
    v_mul_f32 v22, v22, v26
    v_mul_f32 v30, v30, v26
    ds_write_b32 v3, v20 offset:0
    ds_write_b32 v3, v28 offset:128
    ds_write_b32 v3, v21 offset:2176
    ds_write_b32 v3, v29 offset:2304
    ds_write_b32 v3, v22 offset:4352
    ds_write_b32 v3, v30 offset:4480
    s_cmp_lg_u32 s4, 2
    s_cbranch_scc1 L_ncf_1
    v_mul_f32_e64 v24, v11, v11
    v_fma_f32 v24, v12, v12, v24
    v_rcp_f32_e64 v24, v24
    v_add_f32 v25, -1.0, v22
    v_mul_f32 v26, v25, v11
    v_mul_f32 v27, v30, v11
    v_add_f32 v24, v24, v24
    v_fma_f32 v26, v30, v12, v26
    v_fma_f32 v27, -v25, v12, v27
    v_mul_f32_e64 v26, v26, v24
    v_mul_f32 v27, v27, v24
    s_mov_b32 exec_lo, 0
    ds_write_b32 v3, v26 offset:5168
    ds_write_b32 v3, v27 offset:5296
    s_mov_b32 exec_lo, -1
L_ncf_1:
L_m_tab:
    s_waitcnt vmcnt(14)
    v_dot2_f32_bf16 v196, v188, v152, 0
    v_dot2_f32_bf16 v197, v188, v188, 0
    v_dot2_f32_bf16 v196, v189, v152, v196
    v_dot2_f32_bf16 v197, v189, v189, v197
    v_dot2_f32_bf16 v196, v190, v152, v196
    v_dot2_f32_bf16 v197, v190, v190, v197
    v_dot2_f32_bf16 v196, v191, v152, v196
    v_dot2_f32_bf16 v197, v191, v191, v197
    v_dot2_f32_bf16 v196, v192, v152, v196
    v_dot2_f32_bf16 v197, v192, v192, v197
    v_dot2_f32_bf16 v196, v193, v152, v196
    v_dot2_f32_bf16 v197, v193, v193, v197
    v_dot2_f32_bf16 v196, v194, v152, v196
    v_dot2_f32_bf16 v197, v194, v194, v197
    v_dot2_f32_bf16 v196, v195, v152, v196
    v_dot2_f32_bf16 v197, v195, v195, v197
    s_nop 1
    v_add_f32_dpp v196, v196, v196 row_shr:1 row_mask:0xf bank_mask:0xf bound_ctrl:0
    v_add_f32_dpp v197, v197, v197 row_shr:1 row_mask:0xf bank_mask:0xf bound_ctrl:0
    s_nop 0
    v_add_f32_dpp v196, v196, v196 row_shr:2 row_mask:0xf bank_mask:0xf bound_ctrl:0
    v_add_f32_dpp v197, v197, v197 row_shr:2 row_mask:0xf bank_mask:0xf bound_ctrl:0
    s_nop 0
    v_add_f32_dpp v196, v196, v196 row_shr:4 row_mask:0xf bank_mask:0xf bound_ctrl:0
    v_add_f32_dpp v197, v197, v197 row_shr:4 row_mask:0xf bank_mask:0xf bound_ctrl:0
    s_nop 0
    v_add_f32_dpp v196, v196, v196 row_shr:8 row_mask:0xf bank_mask:0xf bound_ctrl:0
    v_add_f32_dpp v197, v197, v197 row_shr:8 row_mask:0xf bank_mask:0xf bound_ctrl:0
    s_nop 0
    v_add_f32_dpp v196, v196, v196 row_bcast:15 row_mask:0xa bank_mask:0xf
    v_add_f32_dpp v197, v197, v197 row_bcast:15 row_mask:0xa bank_mask:0xf
    v_mul_f32 v196, 0x3b000000, v196
    v_mul_f32 v197, 0x3b000000, v197
    v_fma_f32 v197, -v196, v196, v197
    v_max_f32 v197, 0, v197
    v_cvt_pk_bf16_f32 v206, v196, v196
    v_lshlrev_b32_e64 v206, 16, v206
    v_cvt_pk_bf16_f32 v198, v197, v197
    v_lshlrev_b32_e64 v198, 16, v198
    v_add_f32 v198, 0x3727c5ac, v198
    v_cvt_pk_bf16_f32 v198, v198, v198
    v_lshlrev_b32_e64 v198, 16, v198
    v_sqrt_f32 v198, v198
    v_sub_f32 v204, v196, v206
    v_cvt_pk_bf16_f32 v198, v198, v198
    v_lshlrev_b32 v198, 16, v198
    v_rcp_f32 v199, v198
    v_cvt_pk_bf16_f32 v202, v206, v198
    v_mul_f32 v204, v204, v199
    v_mul_f32 v205, v197, v199
    v_cvt_pk_bf16_f32 v204, v204, v204
    v_lshlrev_b32 v204, 16, v204
    v_mul_f32 v205, v205, v199
    v_fma_f32 v200, v204, v198, v206
    v_cvt_pk_bf16_f32 v205, v205, v205
    v_lshlrev_b32_e64 v205, 16, v205
    v_add_f32 v205, 0x3727c5ac, v205
    v_cvt_pk_bf16_f32 v205, v205, v205
    v_lshlrev_b32_e64 v205, 16, v205
    v_sqrt_f32 v205, v205
    v_mov_b32 v203, s10
    v_cvt_pk_bf16_f32 v205, v205, v205
    v_lshlrev_b32_e64 v205, 16, v205
    v_mul_f32 v201, v205, v198
    s_lshl_b32 s86, s4, 5
    s_add_u32 s86, s86, 154256
    v_lshl_add_u32 v196, v250, 4, s86
    v_add_u32 v188, 154256, v254
    s_mov_b32 exec_lo, 0x80000000
    s_mov_b32 exec_hi, 0x80000000
    ds_write_b128 v196, v[200:203] offset:0
    s_mov_b64 exec, -1
L_m_gs:
    s_lshl1_add_u32 s16, s5, s12
    s_lshl_b32 s16, s16, 10
    s_add_u32 s16, s16, 0x8000
    v_lshlrev_b32_e64 v177, 4, v253
    s_bfe_u32 s78, s50, 0x30004
    s_add_u32 m0, s76, 40960
    s_lshl_b32 s77, s78, 7
    buffer_load_dwordx4 v170, s[60:63], s77 offen offset:0 lds
    buffer_load_dwordx4 v171, s[60:63], s77 offen offset:1024 lds
    s_add_u32 m0, s76, 43008
    s_mul_i32 s78, s78, 176128
    buffer_load_dwordx4 v172, s[64:67], s78 offen offset:0 lds
    buffer_load_dwordx4 v173, s[64:67], s78 offen offset:1024 lds
    buffer_load_dwordx4 v174, s[64:67], s78 offen offset:2048 lds
    s_add_u32 m0, s76, 36864
    s_nop 0
    buffer_load_dwordx4 v168, s[52:55], s77 offen offset:0 lds
    buffer_load_dwordx4 v169, s[52:55], s77 offen offset:1024 lds
    s_waitcnt lgkmcnt(0)
L_m_d1:
    s_mov_b64 exec, 0
    s_cmp_eq_u32 s4, 0
    s_cbranch_scc1 L_stub_0
    s_cmp_eq_u32 s4, 1
    s_cbranch_scc1 L_stub_1
    s_cmp_eq_u32 s4, 2
    s_cbranch_scc1 L_stub_2
    s_branch L_stub_3
L_back:
    s_mov_b64 exec, -1
L_m_tch:
    s_branch L_pg_0
.p2align 12
L_pg_0:
    s_waitcnt vmcnt(7)
L_m_st0:
    s_barrier
    ds_read_b128 v[132:135], v160 offset:0
    ds_read_b128 v[100:103], v156 offset:0
    ds_read_b128 v[104:107], v156 offset:9216
    ds_read_b128 v[108:111], v156 offset:2048
    ds_read_b128 v[112:115], v156 offset:11264
    ds_read_b128 v[136:139], v160 offset:9216
    ds_read_b64_tr_b16 v[140:141], v164 offset:0
    ds_read_b64_tr_b16 v[142:143], v164 offset:768
    ds_read_b64_tr_b16 v[144:145], v164 offset:64
    ds_read_b64_tr_b16 v[146:147], v164 offset:832
    ds_read_b64_tr_b16 v[148:149], v164 offset:128
    ds_read_b64_tr_b16 v[150:151], v164 offset:896
    ds_read_b128 v[192:195], v188
    s_waitcnt lgkmcnt(7)
    v_mfma_f32_16x16x32_bf16 v[152:155], v[132:135], v[80:83], 0
    buffer_load_dwordx4 v168, s[52:55], s77 offen offset:2048 lds
    v_mfma_f32_16x16x32_bf16 v[0:3], v[132:135], v[100:103], 0
    ds_read_b128 v[116:119], v158 offset:0
    ds_read_b128 v[120:123], v158 offset:9216
    v_mfma_f32_16x16x32_bf16 v[4:7], v[132:135], v[104:107], 0
    ds_read_b128 v[124:127], v158 offset:2048
    ds_read_b128 v[128:131], v158 offset:11264
    v_mfma_f32_16x16x32_bf16 v[8:11], v[132:135], v[108:111], 0
    s_nop 0
    v_mfma_f32_16x16x32_bf16 v[12:15], v[132:135], v[112:115], 0
    ds_read_b128 v[132:135], v162 offset:0
    v_mfma_f32_16x16x32_bf16 v[152:155], v[136:139], v[84:87], v[152:155]
    buffer_load_dwordx4 v169, s[52:55], s77 offen offset:3072 lds
    v_mfma_f32_16x16x32_bf16 v[16:19], v[136:139], v[100:103], 0
    s_bfe_u32 s78, s50, 0x30008
    s_add_u32 m0, s76, 77824
    v_mfma_f32_16x16x32_bf16 v[20:23], v[136:139], v[104:107], 0
    s_lshl_b32 s77, s78, 7
    v_mfma_f32_16x16x32_bf16 v[24:27], v[136:139], v[108:111], 0
    v_mfma_f32_16x16x32_bf16 v[28:31], v[136:139], v[112:115], 0
    ds_read_b128 v[136:139], v162 offset:9216
    s_waitcnt lgkmcnt(9)
    v_mfma_f32_16x16x32_bf16 v[152:155], v[140:143], v[88:91], v[152:155]
    buffer_load_dwordx4 v170, s[60:63], s77 offen offset:0 lds
    v_mfma_f32_16x16x32_bf16 v[32:35], v[140:143], v[100:103], 0
    v_mfma_f32_16x16x32_bf16 v[36:39], v[140:143], v[104:107], 0
    v_mfma_f32_16x16x32_bf16 v[40:43], v[140:143], v[108:111], 0
    v_mfma_f32_16x16x32_bf16 v[44:47], v[140:143], v[112:115], 0
    ds_read_b64_tr_b16 v[140:141], v166 offset:0
    ds_read_b64_tr_b16 v[142:143], v166 offset:768
    v_mfma_f32_16x16x32_bf16 v[152:155], v[144:147], v[92:95], v[152:155]
    buffer_load_dwordx4 v171, s[60:63], s77 offen offset:1024 lds
    v_mfma_f32_16x16x32_bf16 v[48:51], v[144:147], v[100:103], 0
    s_add_u32 m0, s76, 79872
    s_mul_i32 s78, s78, 176128
    v_mfma_f32_16x16x32_bf16 v[52:55], v[144:147], v[104:107], 0
    v_mfma_f32_16x16x32_bf16 v[56:59], v[144:147], v[108:111], 0
    buffer_load_dwordx4 v172, s[64:67], s78 offen offset:0 lds
    v_mfma_f32_16x16x32_bf16 v[60:63], v[144:147], v[112:115], 0
    ds_read_b64_tr_b16 v[144:145], v166 offset:64
    s_waitcnt lgkmcnt(10)
    s_waitcnt lgkmcnt(9)
    s_cmp_lg_u32 s4, 0
    s_cbranch_scc1 L_gs_2
    s_mov_b64 exec, 0xff
    buffer_store_dwordx4 v[192:195], v254, s[56:59], s38 offen sc1
    s_mov_b64 exec, -1
L_gs_2:
    v_mfma_f32_16x16x32_bf16 v[152:155], v[148:151], v[96:99], v[152:155]
    ds_read_b64_tr_b16 v[146:147], v166 offset:832
    v_mfma_f32_16x16x32_bf16 v[64:67], v[148:151], v[100:103], 0
    v_mfma_f32_16x16x32_bf16 v[68:71], v[148:151], v[104:107], 0
    v_mfma_f32_16x16x32_bf16 v[72:75], v[148:151], v[108:111], 0
    buffer_load_dwordx4 v173, s[64:67], s78 offen offset:1024 lds
    v_mfma_f32_16x16x32_bf16 v[76:79], v[148:151], v[112:115], 0
    ds_read_b64_tr_b16 v[148:149], v166 offset:128
    s_waitcnt lgkmcnt(5)
    v_mfma_f32_16x16x32_bf16 v[0:3], v[132:135], v[116:119], v[0:3]
    ds_read_b64_tr_b16 v[150:151], v166 offset:896
    v_mfma_f32_16x16x32_bf16 v[4:7], v[132:135], v[120:123], v[4:7]
    v_mfma_f32_16x16x32_bf16 v[8:11], v[132:135], v[124:127], v[8:11]
    buffer_load_dwordx4 v174, s[64:67], s78 offen offset:2048 lds
    v_mfma_f32_16x16x32_bf16 v[12:15], v[132:135], v[128:131], v[12:15]
    s_add_u32 m0, s76, 73728
    v_mfma_f32_16x16x32_bf16 v[16:19], v[136:139], v[116:119], v[16:19]
    v_mfma_f32_16x16x32_bf16 v[20:23], v[136:139], v[120:123], v[20:23]
    v_mfma_f32_16x16x32_bf16 v[24:27], v[136:139], v[124:127], v[24:27]
    s_nop 0
    v_mfma_f32_16x16x32_bf16 v[28:31], v[136:139], v[128:131], v[28:31]
    s_waitcnt lgkmcnt(0)
L_m_a0:
    s_waitcnt vmcnt(5)
    s_barrier
    v_mfma_f32_16x16x32_bf16 v[32:35], v[140:143], v[116:119], v[32:35]
    ds_read_b128 v[132:135], v160 offset:36864
    ds_read_b128 v[100:103], v156 offset:36864
    v_mfma_f32_16x16x32_bf16 v[36:39], v[140:143], v[120:123], v[36:39]
    ds_read_b128 v[104:107], v156 offset:46080
    ds_read_b128 v[108:111], v156 offset:38912
    v_mfma_f32_16x16x32_bf16 v[40:43], v[140:143], v[124:127], v[40:43]
    ds_read_b128 v[112:115], v156 offset:48128
    ds_read_b128 v[136:139], v160 offset:46080
    v_mfma_f32_16x16x32_bf16 v[44:47], v[140:143], v[128:131], v[44:47]
    ds_read_b64_tr_b16 v[140:141], v164 offset:36864
    ds_read_b64_tr_b16 v[142:143], v164 offset:37632
    v_mfma_f32_16x16x32_bf16 v[48:51], v[144:147], v[116:119], v[48:51]
    buffer_load_dwordx4 v168, s[52:55], s77 offen offset:0 lds
    v_mfma_f32_16x16x32_bf16 v[52:55], v[144:147], v[120:123], v[52:55]
    buffer_load_dwordx4 v169, s[52:55], s77 offen offset:1024 lds
    v_mfma_f32_16x16x32_bf16 v[56:59], v[144:147], v[124:127], v[56:59]
    buffer_load_dwordx4 v168, s[52:55], s77 offen offset:2048 lds
    v_mfma_f32_16x16x32_bf16 v[60:63], v[144:147], v[128:131], v[60:63]
    ds_read_b64_tr_b16 v[144:145], v164 offset:36928
    ds_read_b64_tr_b16 v[146:147], v164 offset:37696
    v_mfma_f32_16x16x32_bf16 v[64:67], v[148:151], v[116:119], v[64:67]
    v_mfma_f32_16x16x32_bf16 v[68:71], v[148:151], v[120:123], v[68:71]
    v_mfma_f32_16x16x32_bf16 v[72:75], v[148:151], v[124:127], v[72:75]
    buffer_load_dwordx4 v169, s[52:55], s77 offen offset:3072 lds
    v_mfma_f32_16x16x32_bf16 v[76:79], v[148:151], v[128:131], v[76:79]
    ds_read_b64_tr_b16 v[148:149], v164 offset:36992
    s_waitcnt lgkmcnt(5)
    v_mfma_f32_16x16x32_bf16 v[152:155], v[132:135], v[80:83], v[152:155]
    ds_read_b64_tr_b16 v[150:151], v164 offset:37760
    s_bfe_u32 s78, s50, 0x3000c
    v_mfma_f32_16x16x32_bf16 v[0:3], v[132:135], v[100:103], v[0:3]
    ds_read_b128 v[116:119], v158 offset:36864
    ds_read_b128 v[120:123], v158 offset:46080
    v_mfma_f32_16x16x32_bf16 v[4:7], v[132:135], v[104:107], v[4:7]
    ds_read_b128 v[124:127], v158 offset:38912
    ds_read_b128 v[128:131], v158 offset:48128
    v_mfma_f32_16x16x32_bf16 v[8:11], v[132:135], v[108:111], v[8:11]
    s_add_u32 m0, s76, 114688
    s_lshl_b32 s77, s78, 7
    v_mfma_f32_16x16x32_bf16 v[12:15], v[132:135], v[112:115], v[12:15]
    ds_read_b128 v[132:135], v162 offset:36864
    v_mfma_f32_16x16x32_bf16 v[152:155], v[136:139], v[84:87], v[152:155]
    buffer_load_dwordx4 v170, s[60:63], s77 offen offset:0 lds
    v_mfma_f32_16x16x32_bf16 v[16:19], v[136:139], v[100:103], v[16:19]
    v_mfma_f32_16x16x32_bf16 v[20:23], v[136:139], v[104:107], v[20:23]
    buffer_load_dwordx4 v171, s[60:63], s77 offen offset:1024 lds
    v_mfma_f32_16x16x32_bf16 v[24:27], v[136:139], v[108:111], v[24:27]
    s_add_u32 m0, s76, 116736
    s_mul_i32 s78, s78, 176128
    v_mfma_f32_16x16x32_bf16 v[28:31], v[136:139], v[112:115], v[28:31]
    ds_read_b128 v[136:139], v162 offset:46080
    s_waitcnt lgkmcnt(8)
    v_mfma_f32_16x16x32_bf16 v[152:155], v[140:143], v[88:91], v[152:155]
    s_nop 0
    v_mfma_f32_16x16x32_bf16 v[32:35], v[140:143], v[100:103], v[32:35]
    buffer_load_dwordx4 v172, s[64:67], s78 offen offset:0 lds
    v_mfma_f32_16x16x32_bf16 v[36:39], v[140:143], v[104:107], v[36:39]
    v_mfma_f32_16x16x32_bf16 v[40:43], v[140:143], v[108:111], v[40:43]
    v_mfma_f32_16x16x32_bf16 v[44:47], v[140:143], v[112:115], v[44:47]
    ds_read_b64_tr_b16 v[140:141], v166 offset:36864
    ds_read_b64_tr_b16 v[142:143], v166 offset:37632
    v_mfma_f32_16x16x32_bf16 v[152:155], v[144:147], v[92:95], v[152:155]
    v_mfma_f32_16x16x32_bf16 v[48:51], v[144:147], v[100:103], v[48:51]
    buffer_load_dwordx4 v173, s[64:67], s78 offen offset:1024 lds
    v_mfma_f32_16x16x32_bf16 v[52:55], v[144:147], v[104:107], v[52:55]
    v_mfma_f32_16x16x32_bf16 v[56:59], v[144:147], v[108:111], v[56:59]
    v_mfma_f32_16x16x32_bf16 v[60:63], v[144:147], v[112:115], v[60:63]
    ds_read_b64_tr_b16 v[144:145], v166 offset:36928
    s_waitcnt lgkmcnt(9)
    v_mfma_f32_16x16x32_bf16 v[152:155], v[148:151], v[96:99], v[152:155]
    ds_read_b64_tr_b16 v[146:147], v166 offset:37696
    v_mfma_f32_16x16x32_bf16 v[64:67], v[148:151], v[100:103], v[64:67]
    buffer_load_dwordx4 v174, s[64:67], s78 offen offset:2048 lds
    v_mfma_f32_16x16x32_bf16 v[68:71], v[148:151], v[104:107], v[68:71]
    s_add_u32 m0, s76, 110592
    v_mfma_f32_16x16x32_bf16 v[72:75], v[148:151], v[108:111], v[72:75]
    v_mfma_f32_16x16x32_bf16 v[76:79], v[148:151], v[112:115], v[76:79]
    ds_read_b64_tr_b16 v[148:149], v166 offset:36992
    s_waitcnt lgkmcnt(5)
    v_mfma_f32_16x16x32_bf16 v[0:3], v[132:135], v[116:119], v[0:3]
    ds_read_b64_tr_b16 v[150:151], v166 offset:37760
    v_mfma_f32_16x16x32_bf16 v[4:7], v[132:135], v[120:123], v[4:7]
    buffer_load_dwordx4 v168, s[52:55], s77 offen offset:0 lds
    v_mfma_f32_16x16x32_bf16 v[8:11], v[132:135], v[124:127], v[8:11]
    v_mfma_f32_16x16x32_bf16 v[12:15], v[132:135], v[128:131], v[12:15]
    v_mfma_f32_16x16x32_bf16 v[16:19], v[136:139], v[116:119], v[16:19]
    buffer_load_dwordx4 v169, s[52:55], s77 offen offset:1024 lds
    v_mfma_f32_16x16x32_bf16 v[20:23], v[136:139], v[120:123], v[20:23]
    v_mfma_f32_16x16x32_bf16 v[24:27], v[136:139], v[124:127], v[24:27]
    s_nop 0
    v_mfma_f32_16x16x32_bf16 v[28:31], v[136:139], v[128:131], v[28:31]
    s_waitcnt lgkmcnt(0)
L_m_a1:
    s_waitcnt vmcnt(7)
L_m_b1:
    s_barrier
    v_mfma_f32_16x16x32_bf16 v[32:35], v[140:143], v[116:119], v[32:35]
    ds_read_b128 v[132:135], v161 offset:0
    ds_read_b128 v[100:103], v157 offset:0
    v_mfma_f32_16x16x32_bf16 v[36:39], v[140:143], v[120:123], v[36:39]
    ds_read_b128 v[104:107], v157 offset:9216
    ds_read_b128 v[108:111], v157 offset:2048
    v_mfma_f32_16x16x32_bf16 v[40:43], v[140:143], v[124:127], v[40:43]
    ds_read_b128 v[112:115], v157 offset:11264
    ds_read_b128 v[136:139], v161 offset:9216
    v_mfma_f32_16x16x32_bf16 v[44:47], v[140:143], v[128:131], v[44:47]
    ds_read_b64_tr_b16 v[140:141], v165 offset:0
    ds_read_b64_tr_b16 v[142:143], v165 offset:768
    v_mfma_f32_16x16x32_bf16 v[48:51], v[144:147], v[116:119], v[48:51]
    buffer_load_dwordx4 v168, s[52:55], s77 offen offset:2048 lds
    v_mfma_f32_16x16x32_bf16 v[52:55], v[144:147], v[120:123], v[52:55]
    buffer_load_dwordx4 v169, s[52:55], s77 offen offset:3072 lds
    v_mfma_f32_16x16x32_bf16 v[56:59], v[144:147], v[124:127], v[56:59]
    s_cmp_lg_u32 s9, 0
    s_cbranch_scc1 L_pf_3
    s_mov_b64 exec, 0x7ff
    buffer_load_dword v248, v246, s[68:71], s82 offen
    s_mov_b64 exec, s[40:41]
    s_mov_b64 s[72:73], s[26:27]
    buffer_load_dword v248, v245, s[72:75], s79 offen
    s_mov_b64 s[72:73], s[28:29]
    buffer_load_dword v248, v245, s[72:75], s79 offen
    s_mov_b64 exec, -1
L_pf_3:
    v_mfma_f32_16x16x32_bf16 v[60:63], v[144:147], v[128:131], v[60:63]
    ds_read_b64_tr_b16 v[144:145], v165 offset:64
    ds_read_b64_tr_b16 v[146:147], v165 offset:832
    v_mfma_f32_16x16x32_bf16 v[64:67], v[148:151], v[116:119], v[64:67]
    s_bfe_u32 s78, s50, 0x30010
    s_add_u32 m0, s76, 4096
    v_mfma_f32_16x16x32_bf16 v[68:71], v[148:151], v[120:123], v[68:71]
    s_lshl_b32 s77, s78, 7
    v_mfma_f32_16x16x32_bf16 v[72:75], v[148:151], v[124:127], v[72:75]
    buffer_load_dwordx4 v170, s[60:63], s77 offen offset:0 lds
    v_mfma_f32_16x16x32_bf16 v[76:79], v[148:151], v[128:131], v[76:79]
    ds_read_b64_tr_b16 v[148:149], v165 offset:128
    s_waitcnt lgkmcnt(5)
    v_mfma_f32_16x16x32_bf16 v[152:155], v[132:135], v[80:83], v[152:155]
    ds_read_b64_tr_b16 v[150:151], v165 offset:896
    v_mfma_f32_16x16x32_bf16 v[0:3], v[132:135], v[100:103], v[0:3]
    ds_read_b128 v[116:119], v159 offset:0
    ds_read_b128 v[120:123], v159 offset:9216
    v_mfma_f32_16x16x32_bf16 v[4:7], v[132:135], v[104:107], v[4:7]
    ds_read_b128 v[124:127], v159 offset:2048
    ds_read_b128 v[128:131], v159 offset:11264
    v_mfma_f32_16x16x32_bf16 v[8:11], v[132:135], v[108:111], v[8:11]
    buffer_load_dwordx4 v171, s[60:63], s77 offen offset:1024 lds
    v_mfma_f32_16x16x32_bf16 v[12:15], v[132:135], v[112:115], v[12:15]
    ds_read_b128 v[132:135], v163 offset:0
    s_add_u32 m0, s76, 6144
    v_mfma_f32_16x16x32_bf16 v[152:155], v[136:139], v[84:87], v[152:155]
    s_mul_i32 s78, s78, 176128
    v_mfma_f32_16x16x32_bf16 v[16:19], v[136:139], v[100:103], v[16:19]
    buffer_load_dwordx4 v172, s[64:67], s78 offen offset:0 lds
    v_mfma_f32_16x16x32_bf16 v[20:23], v[136:139], v[104:107], v[20:23]
    v_mfma_f32_16x16x32_bf16 v[24:27], v[136:139], v[108:111], v[24:27]
    buffer_load_dwordx4 v173, s[64:67], s78 offen offset:1024 lds
    v_mfma_f32_16x16x32_bf16 v[28:31], v[136:139], v[112:115], v[28:31]
    ds_read_b128 v[136:139], v163 offset:9216
    s_waitcnt lgkmcnt(8)
    v_mfma_f32_16x16x32_bf16 v[152:155], v[140:143], v[88:91], v[152:155]
    s_nop 0
    v_mfma_f32_16x16x32_bf16 v[32:35], v[140:143], v[100:103], v[32:35]
    v_mfma_f32_16x16x32_bf16 v[36:39], v[140:143], v[104:107], v[36:39]
    v_mfma_f32_16x16x32_bf16 v[40:43], v[140:143], v[108:111], v[40:43]
    buffer_load_dwordx4 v174, s[64:67], s78 offen offset:2048 lds
    v_mfma_f32_16x16x32_bf16 v[44:47], v[140:143], v[112:115], v[44:47]
    ds_read_b64_tr_b16 v[140:141], v167 offset:0
    ds_read_b64_tr_b16 v[142:143], v167 offset:768
    v_mfma_f32_16x16x32_bf16 v[152:155], v[144:147], v[92:95], v[152:155]
    s_add_u32 m0, s76, 0
    v_mfma_f32_16x16x32_bf16 v[48:51], v[144:147], v[100:103], v[48:51]
    v_mfma_f32_16x16x32_bf16 v[52:55], v[144:147], v[104:107], v[52:55]
    buffer_load_dwordx4 v168, s[52:55], s77 offen offset:0 lds
    v_mfma_f32_16x16x32_bf16 v[56:59], v[144:147], v[108:111], v[56:59]
    v_mfma_f32_16x16x32_bf16 v[60:63], v[144:147], v[112:115], v[60:63]
    ds_read_b64_tr_b16 v[144:145], v167 offset:64
    s_waitcnt lgkmcnt(9)
    v_mfma_f32_16x16x32_bf16 v[152:155], v[148:151], v[96:99], v[152:155]
    ds_read_b64_tr_b16 v[146:147], v167 offset:832
    v_mfma_f32_16x16x32_bf16 v[64:67], v[148:151], v[100:103], v[64:67]
    v_mfma_f32_16x16x32_bf16 v[68:71], v[148:151], v[104:107], v[68:71]
    buffer_load_dwordx4 v169, s[52:55], s77 offen offset:1024 lds
    v_mfma_f32_16x16x32_bf16 v[72:75], v[148:151], v[108:111], v[72:75]
    v_mfma_f32_16x16x32_bf16 v[76:79], v[148:151], v[112:115], v[76:79]
    ds_read_b64_tr_b16 v[148:149], v167 offset:128
    s_waitcnt lgkmcnt(5)
    v_mfma_f32_16x16x32_bf16 v[0:3], v[132:135], v[116:119], v[0:3]
    ds_read_b64_tr_b16 v[150:151], v167 offset:896
    v_mfma_f32_16x16x32_bf16 v[4:7], v[132:135], v[120:123], v[4:7]
    buffer_load_dwordx4 v168, s[52:55], s77 offen offset:2048 lds
    v_mfma_f32_16x16x32_bf16 v[8:11], v[132:135], v[124:127], v[8:11]
    v_mfma_f32_16x16x32_bf16 v[12:15], v[132:135], v[128:131], v[12:15]
    v_mfma_f32_16x16x32_bf16 v[16:19], v[136:139], v[116:119], v[16:19]
    v_mfma_f32_16x16x32_bf16 v[20:23], v[136:139], v[120:123], v[20:23]
    v_mfma_f32_16x16x32_bf16 v[24:27], v[136:139], v[124:127], v[24:27]
    buffer_load_dwordx4 v169, s[52:55], s77 offen offset:3072 lds
    v_mfma_f32_16x16x32_bf16 v[28:31], v[136:139], v[128:131], v[28:31]
    s_waitcnt lgkmcnt(0)
L_m_a2:
    s_waitcnt vmcnt(9)
    s_barrier
    v_mfma_f32_16x16x32_bf16 v[32:35], v[140:143], v[116:119], v[32:35]
    ds_read_b128 v[132:135], v161 offset:36864
    ds_read_b128 v[100:103], v157 offset:36864
    v_mfma_f32_16x16x32_bf16 v[36:39], v[140:143], v[120:123], v[36:39]
    ds_read_b128 v[104:107], v157 offset:46080
    ds_read_b128 v[108:111], v157 offset:38912
    v_mfma_f32_16x16x32_bf16 v[40:43], v[140:143], v[124:127], v[40:43]
    ds_read_b128 v[112:115], v157 offset:48128
    ds_read_b128 v[136:139], v161 offset:46080
    v_mfma_f32_16x16x32_bf16 v[44:47], v[140:143], v[128:131], v[44:47]
    ds_read_b64_tr_b16 v[140:141], v165 offset:36864
    ds_read_b64_tr_b16 v[142:143], v165 offset:37632
    v_mfma_f32_16x16x32_bf16 v[48:51], v[144:147], v[116:119], v[48:51]
    s_cmp_lg_u32 s9, 1
    s_cbranch_scc1 L_pf_4
    s_mov_b64 exec, 0x7ff
    buffer_load_dword v248, v246, s[68:71], s82 offen
    s_mov_b64 exec, s[40:41]
    s_mov_b64 s[72:73], s[26:27]
    buffer_load_dword v248, v245, s[72:75], s79 offen
    s_mov_b64 s[72:73], s[28:29]
    buffer_load_dword v248, v245, s[72:75], s79 offen
    s_mov_b64 exec, -1
L_pf_4:
    v_mfma_f32_16x16x32_bf16 v[52:55], v[144:147], v[120:123], v[52:55]
    s_bfe_u32 s78, s50, 0x30014
    s_add_u32 m0, s76, 40960
    v_mfma_f32_16x16x32_bf16 v[56:59], v[144:147], v[124:127], v[56:59]
    s_nop 0
    s_lshl_b32 s77, s78, 7
    v_mfma_f32_16x16x32_bf16 v[60:63], v[144:147], v[128:131], v[60:63]
    ds_read_b64_tr_b16 v[144:145], v165 offset:36928
    ds_read_b64_tr_b16 v[146:147], v165 offset:37696
    v_mfma_f32_16x16x32_bf16 v[64:67], v[148:151], v[116:119], v[64:67]
    buffer_load_dwordx4 v170, s[60:63], s77 offen offset:0 lds
    v_mfma_f32_16x16x32_bf16 v[68:71], v[148:151], v[120:123], v[68:71]
    buffer_load_dwordx4 v171, s[60:63], s77 offen offset:1024 lds
    v_mfma_f32_16x16x32_bf16 v[72:75], v[148:151], v[124:127], v[72:75]
    s_add_u32 m0, s76, 43008
    s_mul_i32 s78, s78, 176128
    v_mfma_f32_16x16x32_bf16 v[76:79], v[148:151], v[128:131], v[76:79]
    ds_read_b64_tr_b16 v[148:149], v165 offset:36992
    s_waitcnt lgkmcnt(5)
    v_mfma_f32_16x16x32_bf16 v[152:155], v[132:135], v[80:83], v[152:155]
    s_nop 0
    ds_read_b64_tr_b16 v[150:151], v165 offset:37760
    v_mfma_f32_16x16x32_bf16 v[0:3], v[132:135], v[100:103], v[0:3]
    ds_read_b128 v[116:119], v159 offset:36864
    ds_read_b128 v[120:123], v159 offset:46080
    v_mfma_f32_16x16x32_bf16 v[4:7], v[132:135], v[104:107], v[4:7]
    ds_read_b128 v[124:127], v159 offset:38912
    ds_read_b128 v[128:131], v159 offset:48128
    v_mfma_f32_16x16x32_bf16 v[8:11], v[132:135], v[108:111], v[8:11]
    buffer_load_dwordx4 v172, s[64:67], s78 offen offset:0 lds
    v_mfma_f32_16x16x32_bf16 v[12:15], v[132:135], v[112:115], v[12:15]
    ds_read_b128 v[132:135], v163 offset:36864
    v_mfma_f32_16x16x32_bf16 v[152:155], v[136:139], v[84:87], v[152:155]
    buffer_load_dwordx4 v173, s[64:67], s78 offen offset:1024 lds
    v_mfma_f32_16x16x32_bf16 v[16:19], v[136:139], v[100:103], v[16:19]
    buffer_load_dwordx4 v174, s[64:67], s78 offen offset:2048 lds
    v_mfma_f32_16x16x32_bf16 v[20:23], v[136:139], v[104:107], v[20:23]
    s_add_u32 m0, s76, 36864
    v_mfma_f32_16x16x32_bf16 v[24:27], v[136:139], v[108:111], v[24:27]
    s_nop 0
    v_mfma_f32_16x16x32_bf16 v[28:31], v[136:139], v[112:115], v[28:31]
    ds_read_b128 v[136:139], v163 offset:46080
    s_waitcnt lgkmcnt(8)
    v_mfma_f32_16x16x32_bf16 v[152:155], v[140:143], v[88:91], v[152:155]
    buffer_load_dwordx4 v168, s[52:55], s77 offen offset:0 lds
    v_mfma_f32_16x16x32_bf16 v[32:35], v[140:143], v[100:103], v[32:35]
    v_mfma_f32_16x16x32_bf16 v[36:39], v[140:143], v[104:107], v[36:39]
    v_mfma_f32_16x16x32_bf16 v[40:43], v[140:143], v[108:111], v[40:43]
    v_mfma_f32_16x16x32_bf16 v[44:47], v[140:143], v[112:115], v[44:47]
    ds_read_b64_tr_b16 v[140:141], v167 offset:36864
    ds_read_b64_tr_b16 v[142:143], v167 offset:37632
    v_mfma_f32_16x16x32_bf16 v[152:155], v[144:147], v[92:95], v[152:155]
    buffer_load_dwordx4 v169, s[52:55], s77 offen offset:1024 lds
    v_mfma_f32_16x16x32_bf16 v[48:51], v[144:147], v[100:103], v[48:51]
    v_mfma_f32_16x16x32_bf16 v[52:55], v[144:147], v[104:107], v[52:55]
    v_mfma_f32_16x16x32_bf16 v[56:59], v[144:147], v[108:111], v[56:59]
    v_mfma_f32_16x16x32_bf16 v[60:63], v[144:147], v[112:115], v[60:63]
    ds_read_b64_tr_b16 v[144:145], v167 offset:36928
    s_waitcnt lgkmcnt(9)
    v_mfma_f32_16x16x32_bf16 v[152:155], v[148:151], v[96:99], v[152:155]
    ds_read_b64_tr_b16 v[146:147], v167 offset:37696
    v_mfma_f32_16x16x32_bf16 v[64:67], v[148:151], v[100:103], v[64:67]
    buffer_load_dwordx4 v168, s[52:55], s77 offen offset:2048 lds
    v_mfma_f32_16x16x32_bf16 v[68:71], v[148:151], v[104:107], v[68:71]
    v_mfma_f32_16x16x32_bf16 v[72:75], v[148:151], v[108:111], v[72:75]
    buffer_load_dwordx4 v169, s[52:55], s77 offen offset:3072 lds
    v_mfma_f32_16x16x32_bf16 v[76:79], v[148:151], v[112:115], v[76:79]
    ds_read_b64_tr_b16 v[148:149], v167 offset:36992
    s_waitcnt lgkmcnt(5)
    v_mfma_f32_16x16x32_bf16 v[0:3], v[132:135], v[116:119], v[0:3]
    ds_read_b64_tr_b16 v[150:151], v167 offset:37760
    v_mfma_f32_16x16x32_bf16 v[4:7], v[132:135], v[120:123], v[4:7]
    s_cmp_lg_u32 s9, 2
    s_cbranch_scc1 L_pf_5
    s_mov_b64 exec, 0x7ff
    buffer_load_dword v248, v246, s[68:71], s82 offen
    s_mov_b64 exec, s[40:41]
    s_mov_b64 s[72:73], s[26:27]
    buffer_load_dword v248, v245, s[72:75], s79 offen
    s_mov_b64 s[72:73], s[28:29]
    buffer_load_dword v248, v245, s[72:75], s79 offen
    s_mov_b64 exec, -1
L_pf_5:
    v_mfma_f32_16x16x32_bf16 v[8:11], v[132:135], v[124:127], v[8:11]
    buffer_load_dwordx4 v[188:191], v177, s[56:59], s16 offen offset:0 sc1
    v_mfma_f32_16x16x32_bf16 v[12:15], v[132:135], v[128:131], v[12:15]
    buffer_load_dwordx4 v[192:195], v177, s[56:59], s16 offen offset:256 sc1
    v_mfma_f32_16x16x32_bf16 v[16:19], v[136:139], v[116:119], v[16:19]
    buffer_load_dwordx4 v[196:199], v177, s[56:59], s16 offen offset:512 sc1
    v_mfma_f32_16x16x32_bf16 v[20:23], v[136:139], v[120:123], v[20:23]
    buffer_load_dwordx4 v[200:203], v177, s[56:59], s16 offen offset:768 sc1
    v_mfma_f32_16x16x32_bf16 v[24:27], v[136:139], v[124:127], v[24:27]
    s_bfe_u32 s78, s50, 0x30018
    s_add_u32 m0, s76, 77824
    v_mfma_f32_16x16x32_bf16 v[28:31], v[136:139], v[128:131], v[28:31]
    s_waitcnt lgkmcnt(0)
L_m_a3:
    s_waitcnt vmcnt(13)
L_m_b3:
    s_barrier
    v_mfma_f32_16x16x32_bf16 v[32:35], v[140:143], v[116:119], v[32:35]
    ds_read_b128 v[132:135], v160 offset:0
    ds_read_b128 v[100:103], v156 offset:0
    v_mfma_f32_16x16x32_bf16 v[36:39], v[140:143], v[120:123], v[36:39]
    ds_read_b128 v[104:107], v156 offset:9216
    ds_read_b128 v[108:111], v156 offset:2048
    v_mfma_f32_16x16x32_bf16 v[40:43], v[140:143], v[124:127], v[40:43]
    ds_read_b128 v[112:115], v156 offset:11264
    ds_read_b128 v[136:139], v160 offset:9216
    v_mfma_f32_16x16x32_bf16 v[44:47], v[140:143], v[128:131], v[44:47]
    ds_read_b64_tr_b16 v[140:141], v164 offset:0
    ds_read_b64_tr_b16 v[142:143], v164 offset:768
    v_mfma_f32_16x16x32_bf16 v[48:51], v[144:147], v[116:119], v[48:51]
    s_lshl_b32 s77, s78, 7
    v_lshlrev_b32_e64 v216, 16, v180
    v_mfma_f32_16x16x32_bf16 v[52:55], v[144:147], v[120:123], v[52:55]
    buffer_load_dwordx4 v170, s[60:63], s77 offen offset:0 lds
    v_mfma_f32_16x16x32_bf16 v[56:59], v[144:147], v[124:127], v[56:59]
    buffer_load_dwordx4 v171, s[60:63], s77 offen offset:1024 lds
    v_mfma_f32_16x16x32_bf16 v[60:63], v[144:147], v[128:131], v[60:63]
    ds_read_b64_tr_b16 v[144:145], v164 offset:64
    ds_read_b64_tr_b16 v[146:147], v164 offset:832
    v_mfma_f32_16x16x32_bf16 v[64:67], v[148:151], v[116:119], v[64:67]
    s_add_u32 m0, s76, 79872
    s_mul_i32 s78, s78, 176128
    v_mfma_f32_16x16x32_bf16 v[68:71], v[148:151], v[120:123], v[68:71]
    buffer_load_dwordx4 v172, s[64:67], s78 offen offset:0 lds
    v_mfma_f32_16x16x32_bf16 v[72:75], v[148:151], v[124:127], v[72:75]
    buffer_load_dwordx4 v173, s[64:67], s78 offen offset:1024 lds
    v_mfma_f32_16x16x32_bf16 v[76:79], v[148:151], v[128:131], v[76:79]
    ds_read_b64_tr_b16 v[148:149], v164 offset:128
    s_waitcnt lgkmcnt(5)
    v_mfma_f32_16x16x32_bf16 v[152:155], v[132:135], v[80:83], v[152:155]
    ds_read_b64_tr_b16 v[150:151], v164 offset:896
    v_and_b32 v217, 0xffff0000, v180
    v_mfma_f32_16x16x32_bf16 v[0:3], v[132:135], v[100:103], v[0:3]
    ds_read_b128 v[116:119], v158 offset:0
    ds_read_b128 v[120:123], v158 offset:9216
    v_mfma_f32_16x16x32_bf16 v[4:7], v[132:135], v[104:107], v[4:7]
    ds_read_b128 v[124:127], v158 offset:2048
    ds_read_b128 v[128:131], v158 offset:11264
    v_mfma_f32_16x16x32_bf16 v[8:11], v[132:135], v[108:111], v[8:11]
    buffer_load_dwordx4 v174, s[64:67], s78 offen offset:2048 lds
    v_mfma_f32_16x16x32_bf16 v[12:15], v[132:135], v[112:115], v[12:15]
    ds_read_b128 v[132:135], v162 offset:0
    s_add_u32 m0, s76, 73728
    v_mfma_f32_16x16x32_bf16 v[152:155], v[136:139], v[84:87], v[152:155]
    v_lshlrev_b32 v218, 16, v181
    v_and_b32 v219, 0xffff0000, v181
    v_mfma_f32_16x16x32_bf16 v[16:19], v[136:139], v[100:103], v[16:19]
    v_lshlrev_b32_e64 v220, 16, v182
    v_and_b32 v221, 0xffff0000, v182
    v_mfma_f32_16x16x32_bf16 v[20:23], v[136:139], v[104:107], v[20:23]
    buffer_load_dwordx4 v168, s[52:55], s77 offen offset:0 lds
    v_mfma_f32_16x16x32_bf16 v[24:27], v[136:139], v[108:111], v[24:27]
    v_lshlrev_b32_e64 v222, 16, v183
    v_and_b32 v223, 0xffff0000, v183
    v_mfma_f32_16x16x32_bf16 v[28:31], v[136:139], v[112:115], v[28:31]
    ds_read_b128 v[136:139], v162 offset:9216
    s_waitcnt lgkmcnt(8)
    v_mfma_f32_16x16x32_bf16 v[152:155], v[140:143], v[88:91], v[152:155]
    v_lshlrev_b32 v224, 16, v184
    v_and_b32 v225, 0xffff0000, v184
    v_mfma_f32_16x16x32_bf16 v[32:35], v[140:143], v[100:103], v[32:35]
    buffer_load_dwordx4 v169, s[52:55], s77 offen offset:1024 lds
    v_mfma_f32_16x16x32_bf16 v[36:39], v[140:143], v[104:107], v[36:39]
    v_lshlrev_b32_e64 v226, 16, v185
    v_and_b32 v227, 0xffff0000, v185
    v_mfma_f32_16x16x32_bf16 v[40:43], v[140:143], v[108:111], v[40:43]
    v_mfma_f32_16x16x32_bf16 v[44:47], v[140:143], v[112:115], v[44:47]
    ds_read_b64_tr_b16 v[140:141], v166 offset:0
    ds_read_b64_tr_b16 v[142:143], v166 offset:768
    v_mfma_f32_16x16x32_bf16 v[152:155], v[144:147], v[92:95], v[152:155]
    v_mfma_f32_16x16x32_bf16 v[48:51], v[144:147], v[100:103], v[48:51]
    buffer_load_dwordx4 v168, s[52:55], s77 offen offset:2048 lds
    v_mfma_f32_16x16x32_bf16 v[52:55], v[144:147], v[104:107], v[52:55]
    v_mfma_f32_16x16x32_bf16 v[56:59], v[144:147], v[108:111], v[56:59]
    v_mfma_f32_16x16x32_bf16 v[60:63], v[144:147], v[112:115], v[60:63]
    ds_read_b64_tr_b16 v[144:145], v166 offset:64
    s_waitcnt lgkmcnt(9)
    v_mfma_f32_16x16x32_bf16 v[152:155], v[148:151], v[96:99], v[152:155]
    s_nop 0
    ds_read_b64_tr_b16 v[146:147], v166 offset:832
    v_mfma_f32_16x16x32_bf16 v[64:67], v[148:151], v[100:103], v[64:67]
    buffer_load_dwordx4 v169, s[52:55], s77 offen offset:3072 lds
    v_mfma_f32_16x16x32_bf16 v[68:71], v[148:151], v[104:107], v[68:71]
    s_cmp_lg_u32 s9, 3
    s_cbranch_scc1 L_pf_6
    s_mov_b64 exec, 0x7ff
    buffer_load_dword v248, v246, s[68:71], s82 offen
    s_mov_b64 exec, s[40:41]
    s_mov_b64 s[72:73], s[26:27]
    buffer_load_dword v248, v245, s[72:75], s79 offen
    s_mov_b64 s[72:73], s[28:29]
    buffer_load_dword v248, v245, s[72:75], s79 offen
    s_mov_b64 exec, -1
L_pf_6:
    v_mfma_f32_16x16x32_bf16 v[72:75], v[148:151], v[108:111], v[72:75]
    s_bfe_u32 s78, s50, 0x3001c
    s_add_u32 m0, s76, 114688
    v_mfma_f32_16x16x32_bf16 v[76:79], v[148:151], v[112:115], v[76:79]
    ds_read_b64_tr_b16 v[148:149], v166 offset:128
    s_waitcnt lgkmcnt(5)
    v_mfma_f32_16x16x32_bf16 v[0:3], v[132:135], v[116:119], v[0:3]
    ds_read_b64_tr_b16 v[150:151], v166 offset:896
    s_lshl_b32 s77, s78, 7
    v_mfma_f32_16x16x32_bf16 v[4:7], v[132:135], v[120:123], v[4:7]
    buffer_load_dwordx4 v170, s[60:63], s77 offen offset:0 lds
    v_mfma_f32_16x16x32_bf16 v[8:11], v[132:135], v[124:127], v[8:11]
    v_mfma_f32_16x16x32_bf16 v[12:15], v[132:135], v[128:131], v[12:15]
    v_mfma_f32_16x16x32_bf16 v[16:19], v[136:139], v[116:119], v[16:19]
    buffer_load_dwordx4 v171, s[60:63], s77 offen offset:1024 lds
    v_mfma_f32_16x16x32_bf16 v[20:23], v[136:139], v[120:123], v[20:23]
    s_add_u32 m0, s76, 116736
    s_mul_i32 s78, s78, 176128
    v_mfma_f32_16x16x32_bf16 v[24:27], v[136:139], v[124:127], v[24:27]
    s_nop 0
    v_mfma_f32_16x16x32_bf16 v[28:31], v[136:139], v[128:131], v[28:31]
    s_waitcnt lgkmcnt(0)
L_m_a4:
    s_waitcnt vmcnt(15)
    s_barrier
    v_mfma_f32_16x16x32_bf16 v[32:35], v[140:143], v[116:119], v[32:35]
    ds_read_b128 v[132:135], v160 offset:36864
    ds_read_b128 v[100:103], v156 offset:36864
    v_mfma_f32_16x16x32_bf16 v[36:39], v[140:143], v[120:123], v[36:39]
    ds_read_b128 v[104:107], v156 offset:46080
    ds_read_b128 v[108:111], v156 offset:38912
    v_mfma_f32_16x16x32_bf16 v[40:43], v[140:143], v[124:127], v[40:43]
    ds_read_b128 v[112:115], v156 offset:48128
    ds_read_b128 v[136:139], v160 offset:46080
    v_mfma_f32_16x16x32_bf16 v[44:47], v[140:143], v[128:131], v[44:47]
    ds_read_b64_tr_b16 v[140:141], v164 offset:36864
    ds_read_b64_tr_b16 v[142:143], v164 offset:37632
    v_mfma_f32_16x16x32_bf16 v[48:51], v[144:147], v[116:119], v[48:51]
    buffer_load_dwordx4 v172, s[64:67], s78 offen offset:0 lds
    v_mfma_f32_16x16x32_bf16 v[52:55], v[144:147], v[120:123], v[52:55]
    buffer_load_dwordx4 v173, s[64:67], s78 offen offset:1024 lds
    v_mfma_f32_16x16x32_bf16 v[56:59], v[144:147], v[124:127], v[56:59]
    v_mfma_f32_16x16x32_bf16 v[60:63], v[144:147], v[128:131], v[60:63]
    ds_read_b64_tr_b16 v[144:145], v164 offset:36928
    ds_read_b64_tr_b16 v[146:147], v164 offset:37696
    v_mfma_f32_16x16x32_bf16 v[64:67], v[148:151], v[116:119], v[64:67]
    buffer_load_dwordx4 v174, s[64:67], s78 offen offset:2048 lds
    v_mfma_f32_16x16x32_bf16 v[68:71], v[148:151], v[120:123], v[68:71]
    s_add_u32 m0, s76, 110592
    v_mfma_f32_16x16x32_bf16 v[72:75], v[148:151], v[124:127], v[72:75]
    v_mfma_f32_16x16x32_bf16 v[76:79], v[148:151], v[128:131], v[76:79]
    ds_read_b64_tr_b16 v[148:149], v164 offset:36992
L_stub_0:
    s_cbranch_execz L_back
    s_waitcnt lgkmcnt(5)
    v_mfma_f32_16x16x32_bf16 v[152:155], v[132:135], v[80:83], v[152:155]
    ds_read_b64_tr_b16 v[150:151], v164 offset:37760
    v_mfma_f32_16x16x32_bf16 v[0:3], v[132:135], v[100:103], v[0:3]
    ds_read_b128 v[116:119], v158 offset:36864
    ds_read_b128 v[120:123], v158 offset:46080
    v_mfma_f32_16x16x32_bf16 v[4:7], v[132:135], v[104:107], v[4:7]
    ds_read_b128 v[124:127], v158 offset:38912
    ds_read_b128 v[128:131], v158 offset:48128
    v_mfma_f32_16x16x32_bf16 v[8:11], v[132:135], v[108:111], v[8:11]
    buffer_load_dwordx4 v168, s[52:55], s77 offen offset:0 lds
    v_mfma_f32_16x16x32_bf16 v[12:15], v[132:135], v[112:115], v[12:15]
    ds_read_b128 v[132:135], v162 offset:36864
    v_mfma_f32_16x16x32_bf16 v[152:155], v[136:139], v[84:87], v[152:155]
    buffer_load_dwordx4 v169, s[52:55], s77 offen offset:1024 lds
    v_mfma_f32_16x16x32_bf16 v[16:19], v[136:139], v[100:103], v[16:19]
    v_mfma_f32_16x16x32_bf16 v[20:23], v[136:139], v[104:107], v[20:23]
    v_mfma_f32_16x16x32_bf16 v[24:27], v[136:139], v[108:111], v[24:27]
    buffer_load_dwordx4 v168, s[52:55], s77 offen offset:2048 lds
    v_mfma_f32_16x16x32_bf16 v[28:31], v[136:139], v[112:115], v[28:31]
    ds_read_b128 v[136:139], v162 offset:46080
    s_waitcnt lgkmcnt(8)
    v_mfma_f32_16x16x32_bf16 v[152:155], v[140:143], v[88:91], v[152:155]
    s_nop 0
    v_mfma_f32_16x16x32_bf16 v[32:35], v[140:143], v[100:103], v[32:35]
    v_mfma_f32_16x16x32_bf16 v[36:39], v[140:143], v[104:107], v[36:39]
    v_mfma_f32_16x16x32_bf16 v[40:43], v[140:143], v[108:111], v[40:43]
    buffer_load_dwordx4 v169, s[52:55], s77 offen offset:3072 lds
    v_mfma_f32_16x16x32_bf16 v[44:47], v[140:143], v[112:115], v[44:47]
    ds_read_b64_tr_b16 v[140:141], v166 offset:36864
    ds_read_b64_tr_b16 v[142:143], v166 offset:37632
    v_mfma_f32_16x16x32_bf16 v[152:155], v[144:147], v[92:95], v[152:155]
    s_mov_b64 s[72:73], s[44:45]
    s_mov_b32 s74, 0x400000
    v_mfma_f32_16x16x32_bf16 v[48:51], v[144:147], v[100:103], v[48:51]
    s_lshl_b32 s77, s4, 11
    s_add_u32 m0, s77, 155648
    v_mfma_f32_16x16x32_bf16 v[52:55], v[144:147], v[104:107], v[52:55]
    s_add_u32 s78, s82, 0
    v_mfma_f32_16x16x32_bf16 v[56:59], v[144:147], v[108:111], v[56:59]
    buffer_load_dwordx4 v175, s[68:71], s78 offen offset:0 lds
    v_mfma_f32_16x16x32_bf16 v[60:63], v[144:147], v[112:115], v[60:63]
    ds_read_b64_tr_b16 v[144:145], v166 offset:36928
    s_waitcnt lgkmcnt(9)
    v_mfma_f32_16x16x32_bf16 v[152:155], v[148:151], v[96:99], v[152:155]
    ds_read_b64_tr_b16 v[146:147], v166 offset:37696
    v_mfma_f32_16x16x32_bf16 v[64:67], v[148:151], v[100:103], v[64:67]
    v_mfma_f32_16x16x32_bf16 v[68:71], v[148:151], v[104:107], v[68:71]
    v_mfma_f32_16x16x32_bf16 v[72:75], v[148:151], v[108:111], v[72:75]
    buffer_load_dwordx4 v176, s[68:71], s78 offen offset:1024 lds
    v_mfma_f32_16x16x32_bf16 v[76:79], v[148:151], v[112:115], v[76:79]
    ds_read_b64_tr_b16 v[148:149], v166 offset:36992
    s_waitcnt lgkmcnt(5)
    v_mfma_f32_16x16x32_bf16 v[0:3], v[132:135], v[116:119], v[0:3]
    ds_read_b64_tr_b16 v[150:151], v166 offset:37760
    s_add_u32 m0, s80, 0
    v_mfma_f32_16x16x32_bf16 v[4:7], v[132:135], v[120:123], v[4:7]
    s_add_u32 s78, s82, 98304
    v_mfma_f32_16x16x32_bf16 v[8:11], v[132:135], v[124:127], v[8:11]
    v_mfma_f32_16x16x32_bf16 v[12:15], v[132:135], v[128:131], v[12:15]
    v_mfma_f32_16x16x32_bf16 v[16:19], v[136:139], v[116:119], v[16:19]
    buffer_load_dwordx4 v175, s[68:71], s78 offen offset:0 lds
    v_mfma_f32_16x16x32_bf16 v[20:23], v[136:139], v[120:123], v[20:23]
    v_mfma_f32_16x16x32_bf16 v[24:27], v[136:139], v[124:127], v[24:27]
    s_nop 0
    v_mfma_f32_16x16x32_bf16 v[28:31], v[136:139], v[128:131], v[28:31]
    s_waitcnt lgkmcnt(0)
L_m_a5:
    s_waitcnt vmcnt(12)
    s_barrier
    v_mfma_f32_16x16x32_bf16 v[32:35], v[140:143], v[116:119], v[32:35]
    ds_read_b128 v[132:135], v161 offset:0
    ds_read_b128 v[100:103], v157 offset:0
    v_mfma_f32_16x16x32_bf16 v[36:39], v[140:143], v[120:123], v[36:39]
    ds_read_b128 v[104:107], v157 offset:9216
    ds_read_b128 v[108:111], v157 offset:2048
    v_mfma_f32_16x16x32_bf16 v[40:43], v[140:143], v[124:127], v[40:43]
    ds_read_b128 v[112:115], v157 offset:11264
    ds_read_b128 v[136:139], v161 offset:9216
    v_mfma_f32_16x16x32_bf16 v[44:47], v[140:143], v[128:131], v[44:47]
    ds_read_b64_tr_b16 v[140:141], v165 offset:0
    ds_read_b64_tr_b16 v[142:143], v165 offset:768
    v_mfma_f32_16x16x32_bf16 v[48:51], v[144:147], v[116:119], v[48:51]
    buffer_load_dwordx4 v176, s[68:71], s78 offen offset:1024 lds
    v_mfma_f32_16x16x32_bf16 v[52:55], v[144:147], v[120:123], v[52:55]
    s_add_u32 s78, s82, 194560
    v_mfma_f32_16x16x32_bf16 v[56:59], v[144:147], v[124:127], v[56:59]
    buffer_load_dwordx4 v175, s[68:71], s78 offen offset:2048 lds
    v_mfma_f32_16x16x32_bf16 v[60:63], v[144:147], v[128:131], v[60:63]
    ds_read_b64_tr_b16 v[144:145], v165 offset:64
    ds_read_b64_tr_b16 v[146:147], v165 offset:832
    v_mfma_f32_16x16x32_bf16 v[64:67], v[148:151], v[116:119], v[64:67]
    v_xor_b32 v212, s10, v191
    v_xor_b32 v213, s10, v195
    v_mfma_f32_16x16x32_bf16 v[68:71], v[148:151], v[120:123], v[68:71]
    v_xor_b32 v214, s10, v199
    v_xor_b32 v215, s10, v203
    v_mfma_f32_16x16x32_bf16 v[72:75], v[148:151], v[124:127], v[72:75]
    v_or3_b32 v212, v212, v213, v214
    v_or_b32 v212, v212, v215
    v_mfma_f32_16x16x32_bf16 v[76:79], v[148:151], v[128:131], v[76:79]
    ds_read_b64_tr_b16 v[148:149], v165 offset:128
    s_waitcnt lgkmcnt(5)
    v_mfma_f32_16x16x32_bf16 v[152:155], v[132:135], v[80:83], v[152:155]
    ds_read_b64_tr_b16 v[150:151], v165 offset:896
    v_cmp_ne_u32_e64 vcc, 0, v212
    v_mfma_f32_16x16x32_bf16 v[0:3], v[132:135], v[100:103], v[0:3]
    ds_read_b128 v[116:119], v159 offset:0
    ds_read_b128 v[120:123], v159 offset:9216
    v_mfma_f32_16x16x32_bf16 v[4:7], v[132:135], v[104:107], v[4:7]
    ds_read_b128 v[124:127], v159 offset:2048
    ds_read_b128 v[128:131], v159 offset:11264
    v_mfma_f32_16x16x32_bf16 v[8:11], v[132:135], v[108:111], v[8:11]
    buffer_load_dwordx4 v176, s[68:71], s78 offen offset:3072 lds
    v_mfma_f32_16x16x32_bf16 v[12:15], v[132:135], v[112:115], v[12:15]
    ds_read_b128 v[132:135], v163 offset:0
    s_add_u32 m0, s80, 4096
    v_mfma_f32_16x16x32_bf16 v[152:155], v[136:139], v[84:87], v[152:155]
    s_add_u32 s78, s82, 294912
    v_mfma_f32_16x16x32_bf16 v[16:19], v[136:139], v[100:103], v[16:19]
    buffer_load_dwordx4 v175, s[68:71], s78 offen offset:0 lds
    v_mfma_f32_16x16x32_bf16 v[20:23], v[136:139], v[104:107], v[20:23]
    s_cbranch_vccz L_std_8
    s_mov_b32 s51, 0
L_stl_7:
    buffer_load_dwordx4 v[188:191], v177, s[56:59], s16 offen offset:0 sc1
    buffer_load_dwordx4 v[192:195], v177, s[56:59], s16 offen offset:256 sc1
    buffer_load_dwordx4 v[196:199], v177, s[56:59], s16 offen offset:512 sc1
    buffer_load_dwordx4 v[200:203], v177, s[56:59], s16 offen offset:768 sc1
    s_waitcnt vmcnt(0)
    v_xor_b32 v212, s10, v191
    v_xor_b32_e64 v213, s10, v195
    v_xor_b32 v214, s10, v199
    v_xor_b32 v215, s10, v203
    v_or3_b32 v212, v212, v213, v214
    v_or_b32 v212, v212, v215
    v_cmp_ne_u32 vcc, 0, v212
    s_add_u32 s51, s51, 1
    s_cbranch_vccz L_std_8
    s_cmp_le_u32 s51, 0x20000
    s_cbranch_scc1 L_stl_7
L_std_8:
    v_mfma_f32_16x16x32_bf16 v[24:27], v[136:139], v[108:111], v[24:27]
    v_rcp_f32_e64 v212, v189
    v_mfma_f32_16x16x32_bf16 v[28:31], v[136:139], v[112:115], v[28:31]
    ds_read_b128 v[136:139], v163 offset:9216
    s_waitcnt lgkmcnt(8)
    v_mfma_f32_16x16x32_bf16 v[152:155], v[140:143], v[88:91], v[152:155]
    buffer_load_dwordx4 v176, s[68:71], s78 offen offset:1024 lds
    v_mfma_f32_16x16x32_bf16 v[32:35], v[140:143], v[100:103], v[32:35]
    s_add_u32 s78, s82, 30720
    v_lshlrev_b32_e64 v204, 16, v190
    v_mfma_f32_16x16x32_bf16 v[36:39], v[140:143], v[104:107], v[36:39]
    v_and_b32 v205, 0xffff0000, v190
    v_mfma_f32_16x16x32_bf16 v[40:43], v[140:143], v[108:111], v[40:43]
    v_rcp_f32_e64 v213, v193
    v_mfma_f32_16x16x32_bf16 v[44:47], v[140:143], v[112:115], v[44:47]
    ds_read_b64_tr_b16 v[140:141], v167 offset:0
    ds_read_b64_tr_b16 v[142:143], v167 offset:768
    v_mfma_f32_16x16x32_bf16 v[152:155], v[144:147], v[92:95], v[152:155]
    v_lshlrev_b32_e64 v206, 16, v194
    v_and_b32 v207, 0xffff0000, v194
    v_mfma_f32_16x16x32_bf16 v[48:51], v[144:147], v[100:103], v[48:51]
    buffer_load_dwordx4 v175, s[68:71], s78 offen offset:2048 lds
    v_mfma_f32_16x16x32_bf16 v[52:55], v[144:147], v[104:107], v[52:55]
    v_rcp_f32_e64 v214, v197
    v_mfma_f32_16x16x32_bf16 v[56:59], v[144:147], v[108:111], v[56:59]
    v_lshlrev_b32_e64 v208, 16, v198
    v_and_b32 v209, 0xffff0000, v198
    v_mfma_f32_16x16x32_bf16 v[60:63], v[144:147], v[112:115], v[60:63]
    ds_read_b64_tr_b16 v[144:145], v167 offset:64
    s_waitcnt lgkmcnt(9)
    v_mfma_f32_16x16x32_bf16 v[152:155], v[148:151], v[96:99], v[152:155]
    ds_read_b64_tr_b16 v[146:147], v167 offset:832
    v_mfma_f32_16x16x32_bf16 v[64:67], v[148:151], v[100:103], v[64:67]
    v_rcp_f32 v215, v201
    v_mfma_f32_16x16x32_bf16 v[68:71], v[148:151], v[104:107], v[68:71]
    buffer_load_dwordx4 v176, s[68:71], s78 offen offset:3072 lds
    v_mfma_f32_16x16x32_bf16 v[72:75], v[148:151], v[108:111], v[72:75]
    s_add_u32 m0, s80, 36864
    s_add_u32 s78, s82, 131072
    v_mfma_f32_16x16x32_bf16 v[76:79], v[148:151], v[112:115], v[76:79]
    ds_read_b64_tr_b16 v[148:149], v167 offset:128
    s_waitcnt lgkmcnt(5)
    v_mfma_f32_16x16x32_bf16 v[0:3], v[132:135], v[116:119], v[0:3]
    ds_read_b64_tr_b16 v[150:151], v167 offset:896
    v_lshlrev_b32 v210, 16, v202
    v_mfma_f32_16x16x32_bf16 v[4:7], v[132:135], v[120:123], v[4:7]
    v_and_b32 v211, 0xffff0000, v202
    v_mfma_f32_16x16x32_bf16 v[8:11], v[132:135], v[124:127], v[8:11]
    buffer_load_dwordx4 v175, s[68:71], s78 offen offset:0 lds
    v_mfma_f32_16x16x32_bf16 v[12:15], v[132:135], v[128:131], v[12:15]
    v_rcp_f32_e64 v205, v205
    v_mfma_f32_16x16x32_bf16 v[16:19], v[136:139], v[116:119], v[16:19]
    v_mul_f32 v190, 0xc0135761, v212
    v_mul_f32_e64 v191, v212, v212
    v_mfma_f32_16x16x32_bf16 v[20:23], v[136:139], v[120:123], v[20:23]
    v_rcp_f32_e64 v207, v207
    v_mfma_f32_16x16x32_bf16 v[24:27], v[136:139], v[124:127], v[24:27]
    v_mul_f32 v194, 0xc0135761, v213
    v_mul_f32 v195, v213, v213
    v_mfma_f32_16x16x32_bf16 v[28:31], v[136:139], v[128:131], v[28:31]
    s_waitcnt lgkmcnt(0)
L_m_a6:
    s_waitcnt vmcnt(11)
L_m_b6:
    s_barrier
    v_mfma_f32_16x16x32_bf16 v[32:35], v[140:143], v[116:119], v[32:35]
    ds_read_b128 v[132:135], v161 offset:36864
    ds_read_b128 v[100:103], v157 offset:36864
    v_mfma_f32_16x16x32_bf16 v[36:39], v[140:143], v[120:123], v[36:39]
    ds_read_b128 v[104:107], v157 offset:46080
    ds_read_b128 v[108:111], v157 offset:38912
    v_mfma_f32_16x16x32_bf16 v[40:43], v[140:143], v[124:127], v[40:43]
    ds_read_b128 v[112:115], v157 offset:48128
    ds_read_b128 v[136:139], v161 offset:46080
    v_mfma_f32_16x16x32_bf16 v[44:47], v[140:143], v[128:131], v[44:47]
    ds_read_b64_tr_b16 v[140:141], v165 offset:36864
    ds_read_b64_tr_b16 v[142:143], v165 offset:37632
    v_mfma_f32_16x16x32_bf16 v[48:51], v[144:147], v[116:119], v[48:51]
    buffer_load_dwordx4 v176, s[68:71], s78 offen offset:1024 lds
    v_mfma_f32_16x16x32_bf16 v[52:55], v[144:147], v[120:123], v[52:55]
    s_add_u32 s78, s82, 227328
    v_mfma_f32_16x16x32_bf16 v[56:59], v[144:147], v[124:127], v[56:59]
    buffer_load_dwordx4 v175, s[68:71], s78 offen offset:2048 lds
    v_mfma_f32_16x16x32_bf16 v[60:63], v[144:147], v[128:131], v[60:63]
    ds_read_b64_tr_b16 v[144:145], v165 offset:36928
    ds_read_b64_tr_b16 v[146:147], v165 offset:37696
    v_mfma_f32_16x16x32_bf16 v[64:67], v[148:151], v[116:119], v[64:67]
    v_rcp_f32 v209, v209
    v_mfma_f32_16x16x32_bf16 v[68:71], v[148:151], v[120:123], v[68:71]
    buffer_load_dwordx4 v176, s[68:71], s78 offen offset:3072 lds
    v_mfma_f32_16x16x32_bf16 v[72:75], v[148:151], v[124:127], v[72:75]
    s_add_u32 m0, s80, 40960
    s_add_u32 s78, s82, 327680
    v_mfma_f32_16x16x32_bf16 v[76:79], v[148:151], v[128:131], v[76:79]
    ds_read_b64_tr_b16 v[148:149], v165 offset:36992
    s_waitcnt lgkmcnt(5)
    v_mfma_f32_16x16x32_bf16 v[152:155], v[132:135], v[80:83], v[152:155]
    ds_read_b64_tr_b16 v[150:151], v165 offset:37760
    v_mul_f32 v198, 0xc0135761, v214
    v_mfma_f32_16x16x32_bf16 v[0:3], v[132:135], v[100:103], v[0:3]
    ds_read_b128 v[116:119], v159 offset:36864
    ds_read_b128 v[120:123], v159 offset:46080
    v_mfma_f32_16x16x32_bf16 v[4:7], v[132:135], v[104:107], v[4:7]
    ds_read_b128 v[124:127], v159 offset:38912
    ds_read_b128 v[128:131], v159 offset:48128
    v_mfma_f32_16x16x32_bf16 v[8:11], v[132:135], v[108:111], v[8:11]
    buffer_load_dwordx4 v175, s[68:71], s78 offen offset:0 lds
    v_mfma_f32_16x16x32_bf16 v[12:15], v[132:135], v[112:115], v[12:15]
    ds_read_b128 v[132:135], v163 offset:36864
    v_mul_f32_e64 v199, v214, v214
    v_mfma_f32_16x16x32_bf16 v[152:155], v[136:139], v[84:87], v[152:155]
    v_rcp_f32_e64 v211, v211
    v_mfma_f32_16x16x32_bf16 v[16:19], v[136:139], v[100:103], v[16:19]
    v_mul_f32 v202, 0xc0135761, v215
    v_mul_f32_e64 v203, v215, v215
    v_mfma_f32_16x16x32_bf16 v[20:23], v[136:139], v[104:107], v[20:23]
    v_mul_f32_e64 v191, v191, v190
    v_mul_f32 v191, 0x3d372713, v191
    v_mfma_f32_16x16x32_bf16 v[24:27], v[136:139], v[108:111], v[24:27]
    v_mul_f32 v195, v195, v194
    v_mul_f32 v195, 0x3d372713, v195
    v_mfma_f32_16x16x32_bf16 v[28:31], v[136:139], v[112:115], v[28:31]
    ds_read_b128 v[136:139], v163 offset:46080
    s_waitcnt lgkmcnt(8)
    v_mfma_f32_16x16x32_bf16 v[152:155], v[140:143], v[88:91], v[152:155]
    buffer_load_dwordx4 v176, s[68:71], s78 offen offset:1024 lds
    v_mfma_f32_16x16x32_bf16 v[32:35], v[140:143], v[100:103], v[32:35]
    s_add_u32 s78, s82, 63488
    v_mul_f32_e64 v199, v199, v198
    v_mfma_f32_16x16x32_bf16 v[36:39], v[140:143], v[104:107], v[36:39]
    v_mul_f32 v199, 0x3d372713, v199
    v_mul_f32_e64 v203, v203, v202
    v_mfma_f32_16x16x32_bf16 v[40:43], v[140:143], v[108:111], v[40:43]
    v_mul_f32 v203, 0x3d372713, v203
    v_mfma_f32_16x16x32_bf16 v[44:47], v[140:143], v[112:115], v[44:47]
    ds_read_b64_tr_b16 v[140:141], v167 offset:36864
    ds_read_b64_tr_b16 v[142:143], v167 offset:37632
    v_mfma_f32_16x16x32_bf16 v[152:155], v[144:147], v[92:95], v[152:155]
    buffer_load_dwordx4 v175, s[68:71], s78 offen offset:2048 lds
    v_mfma_f32_16x16x32_bf16 v[48:51], v[144:147], v[100:103], v[48:51]
    v_mfma_f32_16x16x32_bf16 v[52:55], v[144:147], v[104:107], v[52:55]
    v_mfma_f32_16x16x32_bf16 v[56:59], v[144:147], v[108:111], v[56:59]
    v_mfma_f32_16x16x32_bf16 v[60:63], v[144:147], v[112:115], v[60:63]
    ds_read_b64_tr_b16 v[144:145], v167 offset:36928
    s_waitcnt lgkmcnt(9)
    v_mfma_f32_16x16x32_bf16 v[152:155], v[148:151], v[96:99], v[152:155]
    ds_read_b64_tr_b16 v[146:147], v167 offset:37696
    v_mfma_f32_16x16x32_bf16 v[64:67], v[148:151], v[100:103], v[64:67]
    buffer_load_dwordx4 v176, s[68:71], s78 offen offset:3072 lds
    v_mfma_f32_16x16x32_bf16 v[68:71], v[148:151], v[104:107], v[68:71]
    s_add_u32 m0, s81, 0
    s_add_u32 s78, s82, 163840
    v_mfma_f32_16x16x32_bf16 v[72:75], v[148:151], v[108:111], v[72:75]
    v_mfma_f32_16x16x32_bf16 v[76:79], v[148:151], v[112:115], v[76:79]
    ds_read_b64_tr_b16 v[148:149], v167 offset:36992
    s_waitcnt lgkmcnt(5)
    v_mfma_f32_16x16x32_bf16 v[0:3], v[132:135], v[116:119], v[0:3]
    ds_read_b64_tr_b16 v[150:151], v167 offset:37760
    s_mov_b32 exec_lo, 0x1f001f
    s_mov_b32 exec_hi, 0x1f001f
    ds_write_b128 v234, v[152:155]
    s_mov_b64 exec, -1
    v_mfma_f32_16x16x32_bf16 v[4:7], v[132:135], v[120:123], v[4:7]
    ds_read_b128 v[80:83], v247 offset:0
    ds_read_b128 v[84:87], v247 offset:64
    v_mfma_f32_16x16x32_bf16 v[8:11], v[132:135], v[124:127], v[8:11]
    ds_read_b128 v[88:91], v247 offset:128
    ds_read_b128 v[92:95], v247 offset:192
    v_mfma_f32_16x16x32_bf16 v[12:15], v[132:135], v[128:131], v[12:15]
    ds_read_b128 v[96:99], v247 offset:256
    v_mfma_f32_16x16x32_bf16 v[16:19], v[136:139], v[116:119], v[16:19]
    buffer_load_dwordx4 v175, s[68:71], s78 offen offset:0 lds
    v_mfma_f32_16x16x32_bf16 v[20:23], v[136:139], v[120:123], v[20:23]
    v_mfma_f32_16x16x32_bf16 v[24:27], v[136:139], v[124:127], v[24:27]
    buffer_load_dwordx4 v176, s[68:71], s78 offen offset:1024 lds
    v_mfma_f32_16x16x32_bf16 v[28:31], v[136:139], v[128:131], v[28:31]
    s_waitcnt lgkmcnt(0)
L_m_a7:
    s_barrier
    v_mfma_f32_16x16x32_bf16 v[32:35], v[140:143], v[116:119], v[32:35]
    ds_read_b128 v[100:103], v235 offset:0
    ds_read_b128 v[104:107], v235 offset:64
    v_mfma_f32_16x16x32_bf16 v[36:39], v[140:143], v[120:123], v[36:39]
    ds_read_b128 v[108:111], v235 offset:128
    ds_read_b128 v[112:115], v235 offset:192
    v_mfma_f32_16x16x32_bf16 v[40:43], v[140:143], v[124:127], v[40:43]
    ds_read_b128 v[132:135], v235 offset:256
    s_mov_b64 s[60:61], s[26:27]
    v_mfma_f32_16x16x32_bf16 v[44:47], v[140:143], v[128:131], v[44:47]
    v_subrev_u32 v170, s85, v170
    v_subrev_u32 v171, s85, v171
    v_mfma_f32_16x16x32_bf16 v[48:51], v[144:147], v[116:119], v[48:51]
    s_add_u32 m0, s80, 73728
    s_add_u32 s77, s79, 0
    v_mfma_f32_16x16x32_bf16 v[52:55], v[144:147], v[120:123], v[52:55]
    buffer_load_dwordx4 v170, s[60:63], s77 offen offset:0 lds
    v_mfma_f32_16x16x32_bf16 v[56:59], v[144:147], v[124:127], v[56:59]
    v_mfma_f32_16x16x32_bf16 v[60:63], v[144:147], v[128:131], v[60:63]
    buffer_load_dwordx4 v171, s[60:63], s77 offen offset:1024 lds
    v_mfma_f32_16x16x32_bf16 v[64:67], v[148:151], v[116:119], v[64:67]
    s_add_u32 s77, s79, 14336
    v_mfma_f32_16x16x32_bf16 v[68:71], v[148:151], v[120:123], v[68:71]
    v_mfma_f32_16x16x32_bf16 v[72:75], v[148:151], v[124:127], v[72:75]
    s_nop 0
    v_mfma_f32_16x16x32_bf16 v[76:79], v[148:151], v[128:131], v[76:79]
L_m_kloop:
    ds_read_b128 v[116:119], v228 offset:272
    ds_read_b128 v[120:123], v228 offset:400
    ds_read_b128 v[124:127], v228 offset:5712
    ds_read_b128 v[128:131], v228 offset:5840
    s_waitcnt lgkmcnt(4)
    v_pk_add_f32 v[80:81], v[80:81], v[100:101]
    v_pk_add_f32 v[82:83], v[82:83], v[102:103]
    v_pk_add_f32 v[84:85], v[84:85], v[104:105]
    buffer_load_dwordx4 v170, s[60:63], s77 offen offset:2048 lds
    v_pk_add_f32 v[86:87], v[86:87], v[106:107]
    v_pk_add_f32 v[88:89], v[88:89], v[108:109]
    v_pk_add_f32 v[90:91], v[90:91], v[110:111]
    v_pk_add_f32 v[92:93], v[92:93], v[112:113]
    v_pk_add_f32 v[94:95], v[94:95], v[114:115]
    v_pk_add_f32 v[96:97], v[96:97], v[132:133]
    v_pk_add_f32 v[98:99], v[98:99], v[134:135]
    v_pk_fma_f32 v[0:1], v[80:81], v[204:205], v[0:1] op_sel:[0,0,0] op_sel_hi:[1,0,1] neg_lo:[0,1,0] neg_hi:[0,1,0]
    v_pk_fma_f32 v[2:3], v[82:83], v[204:205], v[2:3] op_sel:[0,0,0] op_sel_hi:[1,0,1] neg_lo:[0,1,0] neg_hi:[0,1,0]
    v_pk_fma_f32 v[16:17], v[84:85], v[204:205], v[16:17] op_sel:[0,0,0] op_sel_hi:[1,0,1] neg_lo:[0,1,0] neg_hi:[0,1,0]
    v_pk_fma_f32 v[18:19], v[86:87], v[204:205], v[18:19] op_sel:[0,0,0] op_sel_hi:[1,0,1] neg_lo:[0,1,0] neg_hi:[0,1,0]
    ds_read_b128 v[100:103], v228 offset:544
    ds_read_b128 v[104:107], v228 offset:672
    ds_read_b128 v[108:111], v228 offset:1088
    ds_read_b128 v[112:115], v228 offset:1216
    v_pk_mul_f32 v[0:1], v[0:1], v[204:205] op_sel:[0,1] op_sel_hi:[1,1]
    v_pk_mul_f32 v[2:3], v[2:3], v[204:205] op_sel:[0,1] op_sel_hi:[1,1]
    v_pk_mul_f32 v[16:17], v[16:17], v[204:205] op_sel:[0,1] op_sel_hi:[1,1]
    v_pk_mul_f32 v[18:19], v[18:19], v[204:205] op_sel:[0,1] op_sel_hi:[1,1]
    v_pk_fma_f32 v[4:5], v[80:81], v[206:207], v[4:5] op_sel:[0,0,0] op_sel_hi:[1,0,1] neg_lo:[0,1,0] neg_hi:[0,1,0]
    v_pk_fma_f32 v[6:7], v[82:83], v[206:207], v[6:7] op_sel:[0,0,0] op_sel_hi:[1,0,1] neg_lo:[0,1,0] neg_hi:[0,1,0]
    v_pk_fma_f32 v[20:21], v[84:85], v[206:207], v[20:21] op_sel:[0,0,0] op_sel_hi:[1,0,1] neg_lo:[0,1,0] neg_hi:[0,1,0]
    buffer_load_dwordx4 v171, s[60:63], s77 offen offset:3072 lds
    v_pk_fma_f32 v[22:23], v[86:87], v[206:207], v[22:23] op_sel:[0,0,0] op_sel_hi:[1,0,1] neg_lo:[0,1,0] neg_hi:[0,1,0]
    v_pk_mul_f32 v[4:5], v[4:5], v[206:207] op_sel:[0,1] op_sel_hi:[1,1]
    v_pk_mul_f32 v[6:7], v[6:7], v[206:207] op_sel:[0,1] op_sel_hi:[1,1]
    v_pk_mul_f32 v[20:21], v[20:21], v[206:207] op_sel:[0,1] op_sel_hi:[1,1]
    v_pk_mul_f32 v[22:23], v[22:23], v[206:207] op_sel:[0,1] op_sel_hi:[1,1]
    v_pk_fma_f32 v[8:9], v[80:81], v[208:209], v[8:9] op_sel:[0,0,0] op_sel_hi:[1,0,1] neg_lo:[0,1,0] neg_hi:[0,1,0]
    v_pk_fma_f32 v[10:11], v[82:83], v[208:209], v[10:11] op_sel:[0,0,0] op_sel_hi:[1,0,1] neg_lo:[0,1,0] neg_hi:[0,1,0]
    v_pk_fma_f32 v[24:25], v[84:85], v[208:209], v[24:25] op_sel:[0,0,0] op_sel_hi:[1,0,1] neg_lo:[0,1,0] neg_hi:[0,1,0]
    v_pk_fma_f32 v[26:27], v[86:87], v[208:209], v[26:27] op_sel:[0,0,0] op_sel_hi:[1,0,1] neg_lo:[0,1,0] neg_hi:[0,1,0]
    v_pk_mul_f32 v[8:9], v[8:9], v[208:209] op_sel:[0,1] op_sel_hi:[1,1]
    v_pk_mul_f32 v[10:11], v[10:11], v[208:209] op_sel:[0,1] op_sel_hi:[1,1]
    v_pk_mul_f32 v[24:25], v[24:25], v[208:209] op_sel:[0,1] op_sel_hi:[1,1]
    v_pk_mul_f32 v[26:27], v[26:27], v[208:209] op_sel:[0,1] op_sel_hi:[1,1]
    v_pk_fma_f32 v[12:13], v[80:81], v[210:211], v[12:13] op_sel:[0,0,0] op_sel_hi:[1,0,1] neg_lo:[0,1,0] neg_hi:[0,1,0]
    v_pk_fma_f32 v[14:15], v[82:83], v[210:211], v[14:15] op_sel:[0,0,0] op_sel_hi:[1,0,1] neg_lo:[0,1,0] neg_hi:[0,1,0]
    v_pk_fma_f32 v[28:29], v[84:85], v[210:211], v[28:29] op_sel:[0,0,0] op_sel_hi:[1,0,1] neg_lo:[0,1,0] neg_hi:[0,1,0]
    v_pk_fma_f32 v[30:31], v[86:87], v[210:211], v[30:31] op_sel:[0,0,0] op_sel_hi:[1,0,1] neg_lo:[0,1,0] neg_hi:[0,1,0]
    v_pk_mul_f32 v[12:13], v[12:13], v[210:211] op_sel:[0,1] op_sel_hi:[1,1]
    v_pk_mul_f32 v[14:15], v[14:15], v[210:211] op_sel:[0,1] op_sel_hi:[1,1]
    v_pk_mul_f32 v[28:29], v[28:29], v[210:211] op_sel:[0,1] op_sel_hi:[1,1]
    v_pk_mul_f32 v[30:31], v[30:31], v[210:211] op_sel:[0,1] op_sel_hi:[1,1]
    s_waitcnt lgkmcnt(4)
    s_nop 0
    v_pk_fma_f32 v[4:5], v[0:1], v[124:125], v[4:5]
    s_add_u32 m0, s80, 77824
    s_add_u32 s77, s79, 32768
    buffer_load_dwordx4 v170, s[60:63], s77 offen offset:0 lds
    v_pk_fma_f32 v[6:7], v[2:3], v[126:127], v[6:7]
    v_pk_fma_f32 v[20:21], v[16:17], v[124:125], v[20:21]
    v_pk_fma_f32 v[22:23], v[18:19], v[126:127], v[22:23]
    v_pk_fma_f32 v[4:5], v[16:17], v[128:129], v[4:5] neg_lo:[0,1,0] neg_hi:[0,1,0]
    v_pk_fma_f32 v[6:7], v[18:19], v[130:131], v[6:7] neg_lo:[0,1,0] neg_hi:[0,1,0]
    v_pk_fma_f32 v[20:21], v[0:1], v[128:129], v[20:21]
    v_pk_fma_f32 v[22:23], v[2:3], v[130:131], v[22:23]
    v_pk_fma_f32 v[8:9], v[4:5], v[124:125], v[8:9]
    v_pk_fma_f32 v[10:11], v[6:7], v[126:127], v[10:11]
    v_pk_fma_f32 v[24:25], v[20:21], v[124:125], v[24:25]
    v_pk_fma_f32 v[26:27], v[22:23], v[126:127], v[26:27]
    v_pk_fma_f32 v[8:9], v[20:21], v[128:129], v[8:9] neg_lo:[0,1,0] neg_hi:[0,1,0]
    v_pk_fma_f32 v[10:11], v[22:23], v[130:131], v[10:11] neg_lo:[0,1,0] neg_hi:[0,1,0]
    v_pk_fma_f32 v[24:25], v[4:5], v[128:129], v[24:25]
    v_pk_fma_f32 v[26:27], v[6:7], v[130:131], v[26:27]
    v_pk_fma_f32 v[12:13], v[8:9], v[124:125], v[12:13]
    v_pk_fma_f32 v[14:15], v[10:11], v[126:127], v[14:15]
    v_pk_fma_f32 v[28:29], v[24:25], v[124:125], v[28:29]
    v_pk_fma_f32 v[30:31], v[26:27], v[126:127], v[30:31]
    buffer_load_dwordx4 v171, s[60:63], s77 offen offset:1024 lds
    v_pk_fma_f32 v[12:13], v[24:25], v[128:129], v[12:13] neg_lo:[0,1,0] neg_hi:[0,1,0]
    v_pk_fma_f32 v[14:15], v[26:27], v[130:131], v[14:15] neg_lo:[0,1,0] neg_hi:[0,1,0]
    v_pk_fma_f32 v[28:29], v[8:9], v[128:129], v[28:29]
    v_pk_fma_f32 v[30:31], v[10:11], v[130:131], v[30:31]
    ds_read_b128 v[124:127], v228 offset:2176
    ds_read_b128 v[128:131], v228 offset:2304
    v_mov_b32_dpp v144, v12 row_shr:1 row_mask:0xf bank_mask:0xf bound_ctrl:0
    v_mov_b32_dpp v145, v13 row_shr:1 row_mask:0xf bank_mask:0xf bound_ctrl:0
    v_mov_b32_dpp v146, v14 row_shr:1 row_mask:0xf bank_mask:0xf bound_ctrl:0
    v_mov_b32_dpp v147, v15 row_shr:1 row_mask:0xf bank_mask:0xf bound_ctrl:0
    v_mov_b32_dpp v148, v28 row_shr:1 row_mask:0xf bank_mask:0xf bound_ctrl:0
    v_mov_b32_dpp v149, v29 row_shr:1 row_mask:0xf bank_mask:0xf bound_ctrl:0
    v_mov_b32_dpp v150, v30 row_shr:1 row_mask:0xf bank_mask:0xf bound_ctrl:0
    v_mov_b32_dpp v151, v31 row_shr:1 row_mask:0xf bank_mask:0xf bound_ctrl:0
    s_nop 0
    s_waitcnt lgkmcnt(2)
    v_pk_fma_f32 v[136:137], v[144:145], v[116:117], v[12:13]
    v_pk_fma_f32 v[138:139], v[146:147], v[118:119], v[14:15]
    v_pk_fma_f32 v[140:141], v[148:149], v[116:117], v[28:29]
    v_pk_fma_f32 v[142:143], v[150:151], v[118:119], v[30:31]
    v_pk_fma_f32 v[136:137], v[148:149], v[120:121], v[136:137] neg_lo:[0,1,0] neg_hi:[0,1,0]
    v_pk_fma_f32 v[138:139], v[150:151], v[122:123], v[138:139] neg_lo:[0,1,0] neg_hi:[0,1,0]
    v_pk_fma_f32 v[140:141], v[144:145], v[120:121], v[140:141]
    s_add_u32 s77, s79, 47104
    buffer_load_dwordx4 v170, s[60:63], s77 offen offset:2048 lds
    v_pk_fma_f32 v[142:143], v[146:147], v[122:123], v[142:143]
    ds_read_b32 v116, v230 offset:4352
    ds_read_b32 v117, v230 offset:4480
    ds_read_b32 v118, v230 offset:5440
    ds_read_b32 v119, v230 offset:5568
    ds_read_b32 v120, v231 offset:0
    ds_read_b32 v121, v231 offset:128
    v_mov_b32_dpp v144, v136 row_shr:2 row_mask:0xf bank_mask:0xf bound_ctrl:0
    v_mov_b32_dpp v145, v137 row_shr:2 row_mask:0xf bank_mask:0xf bound_ctrl:0
    v_mov_b32_dpp v146, v138 row_shr:2 row_mask:0xf bank_mask:0xf bound_ctrl:0
    v_mov_b32_dpp v147, v139 row_shr:2 row_mask:0xf bank_mask:0xf bound_ctrl:0
    v_mov_b32_dpp v148, v140 row_shr:2 row_mask:0xf bank_mask:0xf bound_ctrl:0
    v_mov_b32_dpp v149, v141 row_shr:2 row_mask:0xf bank_mask:0xf bound_ctrl:0
    v_mov_b32_dpp v150, v142 row_shr:2 row_mask:0xf bank_mask:0xf bound_ctrl:0
    v_mov_b32_dpp v151, v143 row_shr:2 row_mask:0xf bank_mask:0xf bound_ctrl:0
    v_pk_fma_f32 v[136:137], v[144:145], v[100:101], v[136:137]
    v_pk_fma_f32 v[138:139], v[146:147], v[102:103], v[138:139]
    v_pk_fma_f32 v[140:141], v[148:149], v[100:101], v[140:141]
    v_pk_fma_f32 v[142:143], v[150:151], v[102:103], v[142:143]
    v_pk_fma_f32 v[136:137], v[148:149], v[104:105], v[136:137] neg_lo:[0,1,0] neg_hi:[0,1,0]
    v_pk_fma_f32 v[138:139], v[150:151], v[106:107], v[138:139] neg_lo:[0,1,0] neg_hi:[0,1,0]
    buffer_load_dwordx4 v171, s[60:63], s77 offen offset:3072 lds
    v_pk_fma_f32 v[140:141], v[144:145], v[104:105], v[140:141]
    v_pk_fma_f32 v[142:143], v[146:147], v[106:107], v[142:143]
    v_mov_b32_dpp v144, v136 row_shr:4 row_mask:0xf bank_mask:0xf bound_ctrl:0
    v_mov_b32_dpp v145, v137 row_shr:4 row_mask:0xf bank_mask:0xf bound_ctrl:0
    v_mov_b32_dpp v146, v138 row_shr:4 row_mask:0xf bank_mask:0xf bound_ctrl:0
    v_mov_b32_dpp v147, v139 row_shr:4 row_mask:0xf bank_mask:0xf bound_ctrl:0
    v_mov_b32_dpp v148, v140 row_shr:4 row_mask:0xf bank_mask:0xf bound_ctrl:0
    v_mov_b32_dpp v149, v141 row_shr:4 row_mask:0xf bank_mask:0xf bound_ctrl:0
    v_mov_b32_dpp v150, v142 row_shr:4 row_mask:0xf bank_mask:0xf bound_ctrl:0
    v_mov_b32_dpp v151, v143 row_shr:4 row_mask:0xf bank_mask:0xf bound_ctrl:0
    v_pk_fma_f32 v[136:137], v[144:145], v[108:109], v[136:137]
    v_pk_fma_f32 v[138:139], v[146:147], v[110:111], v[138:139]
    v_pk_fma_f32 v[140:141], v[148:149], v[108:109], v[140:141]
    v_pk_fma_f32 v[142:143], v[150:151], v[110:111], v[142:143]
    v_pk_fma_f32 v[136:137], v[148:149], v[112:113], v[136:137] neg_lo:[0,1,0] neg_hi:[0,1,0]
    v_pk_fma_f32 v[138:139], v[150:151], v[114:115], v[138:139] neg_lo:[0,1,0] neg_hi:[0,1,0]
    v_pk_fma_f32 v[140:141], v[144:145], v[112:113], v[140:141]
    v_pk_fma_f32 v[142:143], v[146:147], v[114:115], v[142:143]
    v_mov_b32_dpp v144, v136 row_shr:8 row_mask:0xf bank_mask:0xf bound_ctrl:0
    v_mov_b32_dpp v145, v137 row_shr:8 row_mask:0xf bank_mask:0xf bound_ctrl:0
    v_mov_b32_dpp v146, v138 row_shr:8 row_mask:0xf bank_mask:0xf bound_ctrl:0
    v_mov_b32_dpp v147, v139 row_shr:8 row_mask:0xf bank_mask:0xf bound_ctrl:0
    s_add_u32 m0, s81, 73728
    s_add_u32 s78, s82, 262144
    buffer_load_dwordx4 v175, s[68:71], s78 offen offset:0 lds
    v_mov_b32_dpp v148, v140 row_shr:8 row_mask:0xf bank_mask:0xf bound_ctrl:0
    v_mov_b32_dpp v149, v141 row_shr:8 row_mask:0xf bank_mask:0xf bound_ctrl:0
    v_mov_b32_dpp v150, v142 row_shr:8 row_mask:0xf bank_mask:0xf bound_ctrl:0
    v_mov_b32_dpp v151, v143 row_shr:8 row_mask:0xf bank_mask:0xf bound_ctrl:0
    s_waitcnt lgkmcnt(6)
    s_nop 0
    v_pk_fma_f32 v[136:137], v[144:145], v[124:125], v[136:137]
    v_pk_fma_f32 v[138:139], v[146:147], v[126:127], v[138:139]
    v_pk_fma_f32 v[140:141], v[148:149], v[124:125], v[140:141]
    v_pk_fma_f32 v[142:143], v[150:151], v[126:127], v[142:143]
    v_pk_fma_f32 v[136:137], v[148:149], v[128:129], v[136:137] neg_lo:[0,1,0] neg_hi:[0,1,0]
    v_pk_fma_f32 v[138:139], v[150:151], v[130:131], v[138:139] neg_lo:[0,1,0] neg_hi:[0,1,0]
    v_pk_fma_f32 v[140:141], v[144:145], v[128:129], v[140:141]
    v_pk_fma_f32 v[142:143], v[146:147], v[130:131], v[142:143]
    s_mov_b32 exec_lo, 0x80008000
    s_mov_b32 exec_hi, 0x80008000
    ds_write_b128 v235, v[136:139]
    ds_write_b128 v235, v[140:143] offset:64
    s_nop 0
    s_mov_b64 exec, -1
    v_mov_b32_dpp v144, v136 row_shr:1 row_mask:0xf bank_mask:0xf bound_ctrl:0
    v_mov_b32_dpp v145, v137 row_shr:1 row_mask:0xf bank_mask:0xf bound_ctrl:0
    v_mov_b32_dpp v146, v138 row_shr:1 row_mask:0xf bank_mask:0xf bound_ctrl:0
    v_mov_b32_dpp v147, v139 row_shr:1 row_mask:0xf bank_mask:0xf bound_ctrl:0
    v_mov_b32_dpp v148, v140 row_shr:1 row_mask:0xf bank_mask:0xf bound_ctrl:0
    v_mov_b32_dpp v149, v141 row_shr:1 row_mask:0xf bank_mask:0xf bound_ctrl:0
    v_mov_b32_dpp v150, v142 row_shr:1 row_mask:0xf bank_mask:0xf bound_ctrl:0
    v_mov_b32_dpp v151, v143 row_shr:1 row_mask:0xf bank_mask:0xf bound_ctrl:0
    v_mov_b32_e64 v114, s10
    v_mov_b32 v115, s10
    s_waitcnt lgkmcnt(0)
    s_barrier
    ds_read2_b32 v[122:123], v233 offset0:160 offset1:176
    ds_read2_b32 v[112:113], v233 offset0:0 offset1:16
    s_cmp_eq_u32 s12, 0
    s_cbranch_scc1 L_np_9
    s_waitcnt lgkmcnt(0)
    v_fma_f32 v112, v122, v116, v112
    v_fma_f32 v113, v122, v117, v113
    v_fma_f32 v112, -v123, v117, v112
    v_fma_f32 v113, v123, v116, v113
    s_mov_b64 exec, 0xffff
    buffer_store_dwordx4 v[112:115], v254, s[56:59], s18 offen sc1
    s_mov_b64 exec, -1
L_np_9:
L_m_Spub:
    v_pk_fma_f32 v[64:65], v[224:225], v[188:189], v[64:65] op_sel:[0,1,0] op_sel_hi:[1,1,1]
    buffer_load_dwordx4 v176, s[68:71], s78 offen offset:1024 lds
    v_pk_fma_f32 v[66:67], v[226:227], v[188:189], v[66:67] op_sel:[0,1,0] op_sel_hi:[1,1,1]
    s_mov_b64 s[60:61], s[28:29]
    s_add_u32 m0, s80, 110592
    s_add_u32 s77, s79, 0
    buffer_load_dwordx4 v170, s[60:63], s77 offen offset:0 lds
    v_pk_fma_f32 v[68:69], v[224:225], v[192:193], v[68:69] op_sel:[0,1,0] op_sel_hi:[1,1,1]
    v_pk_fma_f32 v[70:71], v[226:227], v[192:193], v[70:71] op_sel:[0,1,0] op_sel_hi:[1,1,1]
    v_pk_fma_f32 v[64:65], v[96:97], v[188:189], v[64:65] op_sel:[0,0,0] op_sel_hi:[1,0,1] neg_lo:[0,1,0] neg_hi:[0,1,0]
    v_pk_fma_f32 v[66:67], v[98:99], v[188:189], v[66:67] op_sel:[0,0,0] op_sel_hi:[1,0,1] neg_lo:[0,1,0] neg_hi:[0,1,0]
    v_pk_fma_f32 v[68:69], v[96:97], v[192:193], v[68:69] op_sel:[0,0,0] op_sel_hi:[1,0,1] neg_lo:[0,1,0] neg_hi:[0,1,0]
L_stub_1:
    s_cbranch_execz L_back
    v_pk_fma_f32 v[70:71], v[98:99], v[192:193], v[70:71] op_sel:[0,0,0] op_sel_hi:[1,0,1] neg_lo:[0,1,0] neg_hi:[0,1,0]
    v_pk_mul_f32 v[100:101], v[64:65], v[64:65]
    v_pk_mul_f32 v[102:103], v[66:67], v[66:67]
    v_pk_mul_f32 v[104:105], v[68:69], v[68:69]
    v_pk_mul_f32 v[106:107], v[70:71], v[70:71]
    v_pk_fma_f32 v[100:101], v[100:101], v[190:191], v[190:191] op_sel:[0,1,0] op_sel_hi:[1,1,0]
    buffer_load_dwordx4 v171, s[60:63], s77 offen offset:1024 lds
    v_pk_fma_f32 v[102:103], v[102:103], v[190:191], v[190:191] op_sel:[0,1,0] op_sel_hi:[1,1,0]
    v_pk_fma_f32 v[104:105], v[104:105], v[194:195], v[194:195] op_sel:[0,1,0] op_sel_hi:[1,1,0]
    v_pk_fma_f32 v[106:107], v[106:107], v[194:195], v[194:195] op_sel:[0,1,0] op_sel_hi:[1,1,0]
    v_pk_mul_f32 v[100:101], v[100:101], v[64:65]
    v_pk_mul_f32 v[102:103], v[102:103], v[66:67]
    v_pk_mul_f32 v[104:105], v[104:105], v[68:69]
    v_pk_mul_f32 v[106:107], v[106:107], v[70:71]
    v_exp_f32 v100, v100
    v_exp_f32 v101, v101
    v_exp_f32 v102, v102
    v_exp_f32 v103, v103
    v_exp_f32 v104, v104
    v_exp_f32 v105, v105
    v_exp_f32 v106, v106
    v_exp_f32 v107, v107
    s_add_u32 s77, s79, 14336
    buffer_load_dwordx4 v170, s[60:63], s77 offen offset:2048 lds
    v_pk_fma_f32 v[100:101], v[100:101], v[188:189], v[188:189] op_sel:[0,1,1] op_sel_hi:[1,1,1]
    v_pk_fma_f32 v[102:103], v[102:103], v[188:189], v[188:189] op_sel:[0,1,1] op_sel_hi:[1,1,1]
    v_pk_fma_f32 v[104:105], v[104:105], v[192:193], v[192:193] op_sel:[0,1,1] op_sel_hi:[1,1,1]
    v_pk_fma_f32 v[106:107], v[106:107], v[192:193], v[192:193] op_sel:[0,1,1] op_sel_hi:[1,1,1]
    v_rcp_f32 v100, v100
    v_rcp_f32 v101, v101
    v_rcp_f32 v102, v102
    v_rcp_f32 v103, v103
    v_rcp_f32 v104, v104
    v_rcp_f32 v105, v105
    v_rcp_f32 v106, v106
    v_rcp_f32 v107, v107
    buffer_load_dwordx4 v171, s[60:63], s77 offen offset:3072 lds
    v_pk_mul_f32 v[100:101], v[100:101], v[64:65]
    v_pk_mul_f32 v[102:103], v[102:103], v[66:67]
    v_pk_mul_f32 v[104:105], v[104:105], v[68:69]
    v_pk_mul_f32 v[106:107], v[106:107], v[70:71]
    v_cvt_pk_bf16_f32 v180, v100, v101
    v_cvt_pk_bf16_f32 v182, v104, v105
    v_cvt_pk_bf16_f32 v181, v102, v103
    v_cvt_pk_bf16_f32 v183, v106, v107
    v_permlane16_swap_b32 v180, v182
    s_add_u32 s84, s19, 8192
    s_cmp_eq_u32 s39, 0
    v_permlane16_swap_b32 v181, v183
    s_cbranch_scc1 L_skip_10
    buffer_store_dwordx4 v[180:183], v254, s[56:59], s84 offen offset:0 sc1
L_skip_10:
    v_pk_fma_f32 v[72:73], v[224:225], v[196:197], v[72:73] op_sel:[0,1,0] op_sel_hi:[1,1,1]
    v_pk_fma_f32 v[74:75], v[226:227], v[196:197], v[74:75] op_sel:[0,1,0] op_sel_hi:[1,1,1]
    v_pk_fma_f32 v[76:77], v[224:225], v[200:201], v[76:77] op_sel:[0,1,0] op_sel_hi:[1,1,1]
    v_pk_fma_f32 v[78:79], v[226:227], v[200:201], v[78:79] op_sel:[0,1,0] op_sel_hi:[1,1,1]
    v_pk_fma_f32 v[72:73], v[96:97], v[196:197], v[72:73] op_sel:[0,0,0] op_sel_hi:[1,0,1] neg_lo:[0,1,0] neg_hi:[0,1,0]
    v_pk_fma_f32 v[74:75], v[98:99], v[196:197], v[74:75] op_sel:[0,0,0] op_sel_hi:[1,0,1] neg_lo:[0,1,0] neg_hi:[0,1,0]
    s_add_u32 m0, s80, 114688
    s_add_u32 s77, s79, 32768
    buffer_load_dwordx4 v170, s[60:63], s77 offen offset:0 lds
    v_pk_fma_f32 v[76:77], v[96:97], v[200:201], v[76:77] op_sel:[0,0,0] op_sel_hi:[1,0,1] neg_lo:[0,1,0] neg_hi:[0,1,0]
    v_pk_fma_f32 v[78:79], v[98:99], v[200:201], v[78:79] op_sel:[0,0,0] op_sel_hi:[1,0,1] neg_lo:[0,1,0] neg_hi:[0,1,0]
    v_pk_mul_f32 v[100:101], v[72:73], v[72:73]
    v_pk_mul_f32 v[102:103], v[74:75], v[74:75]
    v_pk_mul_f32 v[104:105], v[76:77], v[76:77]
    v_pk_mul_f32 v[106:107], v[78:79], v[78:79]
    v_pk_fma_f32 v[100:101], v[100:101], v[198:199], v[198:199] op_sel:[0,1,0] op_sel_hi:[1,1,0]
    v_pk_fma_f32 v[102:103], v[102:103], v[198:199], v[198:199] op_sel:[0,1,0] op_sel_hi:[1,1,0]
    v_pk_fma_f32 v[104:105], v[104:105], v[202:203], v[202:203] op_sel:[0,1,0] op_sel_hi:[1,1,0]
    v_pk_fma_f32 v[106:107], v[106:107], v[202:203], v[202:203] op_sel:[0,1,0] op_sel_hi:[1,1,0]
    v_pk_mul_f32 v[100:101], v[100:101], v[72:73]
    v_pk_mul_f32 v[102:103], v[102:103], v[74:75]
    v_pk_mul_f32 v[104:105], v[104:105], v[76:77]
    v_pk_mul_f32 v[106:107], v[106:107], v[78:79]
    v_exp_f32_e64 v100, v100
    v_exp_f32 v101, v101
    v_exp_f32 v102, v102
    buffer_load_dwordx4 v171, s[60:63], s77 offen offset:1024 lds
    v_exp_f32 v103, v103
    v_exp_f32 v104, v104
    v_exp_f32 v105, v105
    v_exp_f32 v106, v106
    v_exp_f32_e64 v107, v107
    v_pk_fma_f32 v[100:101], v[100:101], v[196:197], v[196:197] op_sel:[0,1,1] op_sel_hi:[1,1,1]
    v_pk_fma_f32 v[102:103], v[102:103], v[196:197], v[196:197] op_sel:[0,1,1] op_sel_hi:[1,1,1]
    v_pk_fma_f32 v[104:105], v[104:105], v[200:201], v[200:201] op_sel:[0,1,1] op_sel_hi:[1,1,1]
    v_pk_fma_f32 v[106:107], v[106:107], v[200:201], v[200:201] op_sel:[0,1,1] op_sel_hi:[1,1,1]
    v_rcp_f32 v100, v100
    v_rcp_f32 v101, v101
    v_rcp_f32 v102, v102
    v_rcp_f32 v103, v103
    s_add_u32 s77, s79, 47104
    buffer_load_dwordx4 v170, s[60:63], s77 offen offset:2048 lds
    v_rcp_f32 v104, v104
    v_rcp_f32 v105, v105
    v_rcp_f32 v106, v106
    v_rcp_f32 v107, v107
    v_pk_mul_f32 v[100:101], v[100:101], v[72:73]
    v_pk_mul_f32 v[102:103], v[102:103], v[74:75]
    v_pk_mul_f32 v[104:105], v[104:105], v[76:77]
    v_pk_mul_f32 v[106:107], v[106:107], v[78:79]
    v_cvt_pk_bf16_f32 v184, v100, v101
    v_cvt_pk_bf16_f32 v186, v104, v105
    v_cvt_pk_bf16_f32 v185, v102, v103
    v_cvt_pk_bf16_f32 v187, v106, v107
    v_permlane16_swap_b32 v184, v186
    s_cmp_eq_u32 s39, 0
    v_permlane16_swap_b32 v185, v187
    s_cbranch_scc1 L_skip_11
    buffer_store_dwordx4 v[184:187], v254, s[56:59], s84 offen offset:1024 sc1
L_skip_11:
L_m_g0:
    v_pk_fma_f32 v[32:33], v[216:217], v[188:189], v[32:33] op_sel:[0,1,0] op_sel_hi:[1,1,1]
    buffer_load_dwordx4 v171, s[60:63], s77 offen offset:3072 lds
    v_pk_fma_f32 v[34:35], v[218:219], v[188:189], v[34:35] op_sel:[0,1,0] op_sel_hi:[1,1,1]
    v_pk_fma_f32 v[36:37], v[216:217], v[192:193], v[36:37] op_sel:[0,1,0] op_sel_hi:[1,1,1]
    v_pk_fma_f32 v[38:39], v[218:219], v[192:193], v[38:39] op_sel:[0,1,0] op_sel_hi:[1,1,1]
    v_pk_fma_f32 v[32:33], v[88:89], v[188:189], v[32:33] op_sel:[0,0,0] op_sel_hi:[1,0,1] neg_lo:[0,1,0] neg_hi:[0,1,0]
    v_pk_fma_f32 v[34:35], v[90:91], v[188:189], v[34:35] op_sel:[0,0,0] op_sel_hi:[1,0,1] neg_lo:[0,1,0] neg_hi:[0,1,0]
    v_pk_fma_f32 v[36:37], v[88:89], v[192:193], v[36:37] op_sel:[0,0,0] op_sel_hi:[1,0,1] neg_lo:[0,1,0] neg_hi:[0,1,0]
    v_pk_fma_f32 v[38:39], v[90:91], v[192:193], v[38:39] op_sel:[0,0,0] op_sel_hi:[1,0,1] neg_lo:[0,1,0] neg_hi:[0,1,0]
    v_pk_mul_f32 v[100:101], v[32:33], v[32:33]
    v_pk_mul_f32 v[102:103], v[34:35], v[34:35]
    v_pk_mul_f32 v[104:105], v[36:37], v[36:37]
    v_pk_mul_f32 v[106:107], v[38:39], v[38:39]
    v_pk_fma_f32 v[100:101], v[100:101], v[190:191], v[190:191] op_sel:[0,1,0] op_sel_hi:[1,1,0]
    v_pk_fma_f32 v[102:103], v[102:103], v[190:191], v[190:191] op_sel:[0,1,0] op_sel_hi:[1,1,0]
    v_pk_fma_f32 v[104:105], v[104:105], v[194:195], v[194:195] op_sel:[0,1,0] op_sel_hi:[1,1,0]
    v_pk_fma_f32 v[106:107], v[106:107], v[194:195], v[194:195] op_sel:[0,1,0] op_sel_hi:[1,1,0]
    v_pk_mul_f32 v[100:101], v[100:101], v[32:33]
    v_pk_mul_f32 v[102:103], v[102:103], v[34:35]
    v_pk_mul_f32 v[104:105], v[104:105], v[36:37]
    v_pk_mul_f32 v[106:107], v[106:107], v[38:39]
    v_exp_f32 v100, v100
    v_exp_f32 v101, v101
    v_exp_f32 v102, v102
    v_exp_f32 v103, v103
    v_exp_f32 v104, v104
    v_exp_f32 v105, v105
    v_exp_f32 v106, v106
    v_exp_f32 v107, v107
    v_pk_fma_f32 v[100:101], v[100:101], v[188:189], v[188:189] op_sel:[0,1,1] op_sel_hi:[1,1,1]
    v_pk_fma_f32 v[102:103], v[102:103], v[188:189], v[188:189] op_sel:[0,1,1] op_sel_hi:[1,1,1]
    v_pk_fma_f32 v[104:105], v[104:105], v[192:193], v[192:193] op_sel:[0,1,1] op_sel_hi:[1,1,1]
    v_pk_fma_f32 v[106:107], v[106:107], v[192:193], v[192:193] op_sel:[0,1,1] op_sel_hi:[1,1,1]
    v_rcp_f32 v100, v100
    v_rcp_f32 v101, v101
    v_rcp_f32 v102, v102
    v_rcp_f32 v103, v103
    v_rcp_f32 v104, v104
    v_rcp_f32 v105, v105
    v_rcp_f32 v106, v106
    v_rcp_f32 v107, v107
    v_pk_mul_f32 v[100:101], v[100:101], v[32:33]
    v_pk_mul_f32 v[102:103], v[102:103], v[34:35]
    v_pk_mul_f32 v[104:105], v[104:105], v[36:37]
    v_pk_mul_f32 v[106:107], v[106:107], v[38:39]
    v_cvt_pk_bf16_f32 v180, v100, v101
    v_cvt_pk_bf16_f32 v182, v104, v105
    v_cvt_pk_bf16_f32 v181, v102, v103
    v_cvt_pk_bf16_f32 v183, v106, v107
    s_nop 0
    v_permlane16_swap_b32 v180, v182
    s_nop 0
    v_permlane16_swap_b32 v181, v183
    buffer_store_dwordx4 v[180:183], v254, s[56:59], s19 offen offset:0 sc1
    v_pk_fma_f32 v[40:41], v[216:217], v[196:197], v[40:41] op_sel:[0,1,0] op_sel_hi:[1,1,1]
    v_pk_fma_f32 v[42:43], v[218:219], v[196:197], v[42:43] op_sel:[0,1,0] op_sel_hi:[1,1,1]
    v_pk_fma_f32 v[44:45], v[216:217], v[200:201], v[44:45] op_sel:[0,1,0] op_sel_hi:[1,1,1]
    v_pk_fma_f32 v[46:47], v[218:219], v[200:201], v[46:47] op_sel:[0,1,0] op_sel_hi:[1,1,1]
    v_pk_fma_f32 v[40:41], v[88:89], v[196:197], v[40:41] op_sel:[0,0,0] op_sel_hi:[1,0,1] neg_lo:[0,1,0] neg_hi:[0,1,0]
    v_pk_fma_f32 v[42:43], v[90:91], v[196:197], v[42:43] op_sel:[0,0,0] op_sel_hi:[1,0,1] neg_lo:[0,1,0] neg_hi:[0,1,0]
    v_pk_fma_f32 v[44:45], v[88:89], v[200:201], v[44:45] op_sel:[0,0,0] op_sel_hi:[1,0,1] neg_lo:[0,1,0] neg_hi:[0,1,0]
    v_pk_fma_f32 v[46:47], v[90:91], v[200:201], v[46:47] op_sel:[0,0,0] op_sel_hi:[1,0,1] neg_lo:[0,1,0] neg_hi:[0,1,0]
    v_pk_mul_f32 v[100:101], v[40:41], v[40:41]
    v_pk_mul_f32 v[102:103], v[42:43], v[42:43]
    v_pk_mul_f32 v[104:105], v[44:45], v[44:45]
    v_pk_mul_f32 v[106:107], v[46:47], v[46:47]
    v_pk_fma_f32 v[100:101], v[100:101], v[198:199], v[198:199] op_sel:[0,1,0] op_sel_hi:[1,1,0]
    v_pk_fma_f32 v[102:103], v[102:103], v[198:199], v[198:199] op_sel:[0,1,0] op_sel_hi:[1,1,0]
    v_pk_fma_f32 v[104:105], v[104:105], v[202:203], v[202:203] op_sel:[0,1,0] op_sel_hi:[1,1,0]
    v_pk_fma_f32 v[106:107], v[106:107], v[202:203], v[202:203] op_sel:[0,1,0] op_sel_hi:[1,1,0]
    v_pk_mul_f32 v[100:101], v[100:101], v[40:41]
    v_pk_mul_f32 v[102:103], v[102:103], v[42:43]
    v_pk_mul_f32 v[104:105], v[104:105], v[44:45]
    v_pk_mul_f32 v[106:107], v[106:107], v[46:47]
    v_exp_f32 v100, v100
    v_exp_f32 v101, v101
    v_exp_f32 v102, v102
    v_exp_f32 v103, v103
    v_exp_f32 v104, v104
    v_exp_f32 v105, v105
    v_exp_f32 v106, v106
    v_exp_f32 v107, v107
    v_pk_fma_f32 v[100:101], v[100:101], v[196:197], v[196:197] op_sel:[0,1,1] op_sel_hi:[1,1,1]
    v_pk_fma_f32 v[102:103], v[102:103], v[196:197], v[196:197] op_sel:[0,1,1] op_sel_hi:[1,1,1]
    v_pk_fma_f32 v[104:105], v[104:105], v[200:201], v[200:201] op_sel:[0,1,1] op_sel_hi:[1,1,1]
    v_pk_fma_f32 v[106:107], v[106:107], v[200:201], v[200:201] op_sel:[0,1,1] op_sel_hi:[1,1,1]
    v_rcp_f32 v100, v100
    v_rcp_f32 v101, v101
    v_rcp_f32 v102, v102
    v_rcp_f32 v103, v103
    v_rcp_f32 v104, v104
    v_rcp_f32 v105, v105
    v_rcp_f32 v106, v106
    v_rcp_f32 v107, v107
    v_pk_mul_f32 v[100:101], v[100:101], v[40:41]
    v_pk_mul_f32 v[102:103], v[102:103], v[42:43]
    v_pk_mul_f32 v[104:105], v[104:105], v[44:45]
    v_pk_mul_f32 v[106:107], v[106:107], v[46:47]
    v_cvt_pk_bf16_f32 v184, v100, v101
    v_cvt_pk_bf16_f32 v186, v104, v105
    v_cvt_pk_bf16_f32 v185, v102, v103
    v_cvt_pk_bf16_f32 v187, v106, v107
    v_permlane16_swap_b32 v184, v186
    s_nop 0
    v_permlane16_swap_b32 v185, v187
    s_nop 0
    buffer_store_dwordx4 v[184:187], v254, s[56:59], s19 offen offset:1024 sc1
L_m_g1:
    v_pk_fma_f32 v[48:49], v[220:221], v[188:189], v[48:49] op_sel:[0,1,0] op_sel_hi:[1,1,1]
    v_pk_fma_f32 v[50:51], v[222:223], v[188:189], v[50:51] op_sel:[0,1,0] op_sel_hi:[1,1,1]
    v_pk_fma_f32 v[52:53], v[220:221], v[192:193], v[52:53] op_sel:[0,1,0] op_sel_hi:[1,1,1]
    v_pk_fma_f32 v[54:55], v[222:223], v[192:193], v[54:55] op_sel:[0,1,0] op_sel_hi:[1,1,1]
    v_pk_fma_f32 v[48:49], v[92:93], v[188:189], v[48:49] op_sel:[0,0,0] op_sel_hi:[1,0,1] neg_lo:[0,1,0] neg_hi:[0,1,0]
    v_pk_fma_f32 v[50:51], v[94:95], v[188:189], v[50:51] op_sel:[0,0,0] op_sel_hi:[1,0,1] neg_lo:[0,1,0] neg_hi:[0,1,0]
    v_pk_fma_f32 v[52:53], v[92:93], v[192:193], v[52:53] op_sel:[0,0,0] op_sel_hi:[1,0,1] neg_lo:[0,1,0] neg_hi:[0,1,0]
    v_pk_fma_f32 v[54:55], v[94:95], v[192:193], v[54:55] op_sel:[0,0,0] op_sel_hi:[1,0,1] neg_lo:[0,1,0] neg_hi:[0,1,0]
    v_pk_mul_f32 v[100:101], v[48:49], v[48:49]
    v_pk_mul_f32 v[102:103], v[50:51], v[50:51]
    v_pk_mul_f32 v[104:105], v[52:53], v[52:53]
    v_pk_mul_f32 v[106:107], v[54:55], v[54:55]
    v_pk_fma_f32 v[100:101], v[100:101], v[190:191], v[190:191] op_sel:[0,1,0] op_sel_hi:[1,1,0]
    v_pk_fma_f32 v[102:103], v[102:103], v[190:191], v[190:191] op_sel:[0,1,0] op_sel_hi:[1,1,0]
    v_pk_fma_f32 v[104:105], v[104:105], v[194:195], v[194:195] op_sel:[0,1,0] op_sel_hi:[1,1,0]
    v_pk_fma_f32 v[106:107], v[106:107], v[194:195], v[194:195] op_sel:[0,1,0] op_sel_hi:[1,1,0]
    v_pk_mul_f32 v[100:101], v[100:101], v[48:49]
    v_pk_mul_f32 v[102:103], v[102:103], v[50:51]
    v_pk_mul_f32 v[104:105], v[104:105], v[52:53]
    v_pk_mul_f32 v[106:107], v[106:107], v[54:55]
    v_exp_f32 v100, v100
    v_exp_f32 v101, v101
    v_exp_f32 v102, v102
    v_exp_f32 v103, v103
    v_exp_f32 v104, v104
    v_exp_f32 v105, v105
    v_exp_f32 v106, v106
    v_exp_f32 v107, v107
    v_pk_fma_f32 v[100:101], v[100:101], v[188:189], v[188:189] op_sel:[0,1,1] op_sel_hi:[1,1,1]
    v_pk_fma_f32 v[102:103], v[102:103], v[188:189], v[188:189] op_sel:[0,1,1] op_sel_hi:[1,1,1]
    v_pk_fma_f32 v[104:105], v[104:105], v[192:193], v[192:193] op_sel:[0,1,1] op_sel_hi:[1,1,1]
    v_pk_fma_f32 v[106:107], v[106:107], v[192:193], v[192:193] op_sel:[0,1,1] op_sel_hi:[1,1,1]
    v_rcp_f32 v100, v100
    v_rcp_f32 v101, v101
    v_rcp_f32 v102, v102
    v_rcp_f32 v103, v103
    v_rcp_f32 v104, v104
    v_rcp_f32 v105, v105
    v_rcp_f32 v106, v106
    v_rcp_f32 v107, v107
    v_pk_mul_f32 v[100:101], v[100:101], v[48:49]
    v_pk_mul_f32 v[102:103], v[102:103], v[50:51]
    v_pk_mul_f32 v[104:105], v[104:105], v[52:53]
    v_pk_mul_f32 v[106:107], v[106:107], v[54:55]
    v_cvt_pk_bf16_f32 v180, v100, v101
    v_cvt_pk_bf16_f32 v182, v104, v105
    v_cvt_pk_bf16_f32 v181, v102, v103
    v_cvt_pk_bf16_f32 v183, v106, v107
    v_permlane16_swap_b32 v180, v182
    s_add_u32 s84, s19, 4096
    v_permlane16_swap_b32 v181, v183
    buffer_store_dwordx4 v[180:183], v254, s[56:59], s84 offen offset:0 sc1
    v_pk_fma_f32 v[56:57], v[220:221], v[196:197], v[56:57] op_sel:[0,1,0] op_sel_hi:[1,1,1]
    v_pk_fma_f32 v[58:59], v[222:223], v[196:197], v[58:59] op_sel:[0,1,0] op_sel_hi:[1,1,1]
    v_pk_fma_f32 v[60:61], v[220:221], v[200:201], v[60:61] op_sel:[0,1,0] op_sel_hi:[1,1,1]
    v_pk_fma_f32 v[62:63], v[222:223], v[200:201], v[62:63] op_sel:[0,1,0] op_sel_hi:[1,1,1]
    v_pk_fma_f32 v[56:57], v[92:93], v[196:197], v[56:57] op_sel:[0,0,0] op_sel_hi:[1,0,1] neg_lo:[0,1,0] neg_hi:[0,1,0]
    v_pk_fma_f32 v[58:59], v[94:95], v[196:197], v[58:59] op_sel:[0,0,0] op_sel_hi:[1,0,1] neg_lo:[0,1,0] neg_hi:[0,1,0]
    v_pk_fma_f32 v[60:61], v[92:93], v[200:201], v[60:61] op_sel:[0,0,0] op_sel_hi:[1,0,1] neg_lo:[0,1,0] neg_hi:[0,1,0]
    v_pk_fma_f32 v[62:63], v[94:95], v[200:201], v[62:63] op_sel:[0,0,0] op_sel_hi:[1,0,1] neg_lo:[0,1,0] neg_hi:[0,1,0]
    v_pk_mul_f32 v[100:101], v[56:57], v[56:57]
    v_pk_mul_f32 v[102:103], v[58:59], v[58:59]
    v_pk_mul_f32 v[104:105], v[60:61], v[60:61]
    v_pk_mul_f32 v[106:107], v[62:63], v[62:63]
    v_pk_fma_f32 v[100:101], v[100:101], v[198:199], v[198:199] op_sel:[0,1,0] op_sel_hi:[1,1,0]
    v_pk_fma_f32 v[102:103], v[102:103], v[198:199], v[198:199] op_sel:[0,1,0] op_sel_hi:[1,1,0]
    v_pk_fma_f32 v[104:105], v[104:105], v[202:203], v[202:203] op_sel:[0,1,0] op_sel_hi:[1,1,0]
    v_pk_fma_f32 v[106:107], v[106:107], v[202:203], v[202:203] op_sel:[0,1,0] op_sel_hi:[1,1,0]
    v_pk_mul_f32 v[100:101], v[100:101], v[56:57]
    v_pk_mul_f32 v[102:103], v[102:103], v[58:59]
    v_pk_mul_f32 v[104:105], v[104:105], v[60:61]
    v_pk_mul_f32 v[106:107], v[106:107], v[62:63]
    v_exp_f32 v100, v100
    v_exp_f32 v101, v101
    v_exp_f32 v102, v102
    v_exp_f32 v103, v103
    v_exp_f32 v104, v104
    v_exp_f32 v105, v105
    v_exp_f32 v106, v106
    v_exp_f32 v107, v107
    v_pk_fma_f32 v[100:101], v[100:101], v[196:197], v[196:197] op_sel:[0,1,1] op_sel_hi:[1,1,1]
    v_pk_fma_f32 v[102:103], v[102:103], v[196:197], v[196:197] op_sel:[0,1,1] op_sel_hi:[1,1,1]
    v_pk_fma_f32 v[104:105], v[104:105], v[200:201], v[200:201] op_sel:[0,1,1] op_sel_hi:[1,1,1]
    v_pk_fma_f32 v[106:107], v[106:107], v[200:201], v[200:201] op_sel:[0,1,1] op_sel_hi:[1,1,1]
    v_rcp_f32 v100, v100
    v_rcp_f32 v101, v101
    v_rcp_f32 v102, v102
    v_rcp_f32 v103, v103
    v_rcp_f32 v104, v104
    v_rcp_f32 v105, v105
    v_rcp_f32 v106, v106
    v_rcp_f32 v107, v107
    v_pk_mul_f32 v[100:101], v[100:101], v[56:57]
    v_pk_mul_f32 v[102:103], v[102:103], v[58:59]
    v_pk_mul_f32 v[104:105], v[104:105], v[60:61]
    v_pk_mul_f32 v[106:107], v[106:107], v[62:63]
    v_cvt_pk_bf16_f32 v184, v100, v101
    v_cvt_pk_bf16_f32 v186, v104, v105
    v_cvt_pk_bf16_f32 v185, v102, v103
    v_cvt_pk_bf16_f32 v187, v106, v107
    s_nop 0
    v_permlane16_swap_b32 v184, v186
    s_nop 0
    v_permlane16_swap_b32 v185, v187
    buffer_store_dwordx4 v[184:187], v254, s[56:59], s84 offen offset:1024 sc1
L_m_gelu:
    buffer_load_dwordx4 v[152:155], v240, s[56:59], s17 offen sc1
    buffer_load_dwordx4 v[156:159], v241, s[56:59], s17 offen sc1
    buffer_load_dwordx4 v[160:163], v242, s[56:59], s17 offen sc1
    buffer_load_dwordx4 v[164:167], v243, s[56:59], s17 offen sc1
    ds_read_b128 v[124:127], v229 offset:0
    ds_read_b128 v[128:131], v229 offset:128
    ds_read_b128 v[100:103], v228 offset:5712
    ds_read_b128 v[104:107], v228 offset:5840
    ds_read_b128 v[108:111], v228 offset:5984
    ds_read_b128 v[112:115], v228 offset:6112
    ds_read_b128 v[80:83], v228 offset:6256
    ds_read_b128 v[84:87], v228 offset:6384
    ds_read_b128 v[88:91], v228 offset:272
    ds_read_b128 v[92:95], v228 offset:400
    ds_read_b128 v[188:191], v228 offset:6528
    ds_read_b128 v[192:195], v228 offset:6656
    s_lshl_b32 s86, s4, 11
    s_add_u32 s86, s86, 155648
    s_add_u32 s87, s81, 73728
    v_add_u32 v32, s86, v178
    v_xor_b32 v33, 64, v32
    v_add_u32 v34, s80, v178
    v_xor_b32 v35, 64, v34
    v_add_u32 v36, s81, v178
    v_xor_b32 v37, 64, v36
    v_add_u32 v38, s87, v178
    v_xor_b32_e64 v39, 64, v38
    v_bfe_u32 v40, v255, 1, 3
    v_xor_b32 v40, v40, v250
    v_lshlrev_b32 v40, 4, v40
    v_lshl_add_u32 v40, v251, 7, v40
    s_add_u32 s86, s80, 73728
    v_add_u32 v40, s86, v40
    v_xor_b32 v41, 32, v40
    v_xor_b32 v42, 64, v40
    v_xor_b32 v43, 96, v40
    buffer_load_dwordx2 a[240:241], v238, s[52:55], 0 offen offset:0
    buffer_load_dwordx2 a[242:243], v238, s[52:55], 0 offen offset:1024
    buffer_load_dwordx2 a[244:245], v238, s[52:55], 0 offen offset:2048
    buffer_load_dwordx2 a[246:247], v238, s[52:55], 0 offen offset:3072
    s_waitcnt vmcnt(12)
    ds_read_b64_tr_b16 a[0:1], v32 offset:0
    ds_read_b64_tr_b16 a[2:3], v32 offset:512
    ds_read_b64_tr_b16 a[4:5], v33 offset:0
    buffer_load_dword a252, v239, s[56:59], s31 offen offset:0 sc1
    ds_read_b64_tr_b16 a[6:7], v33 offset:512
    ds_read_b64_tr_b16 a[8:9], v34 offset:0
    ds_read_b64_tr_b16 a[10:11], v34 offset:512
    ds_read_b64_tr_b16 a[12:13], v35 offset:0
    buffer_load_dword a253, v239, s[56:59], s31 offen offset:256 sc1
    ds_read_b64_tr_b16 a[14:15], v35 offset:512
    ds_read_b64_tr_b16 a[16:17], v34 offset:2048
    ds_read_b64_tr_b16 a[18:19], v34 offset:2560
    ds_read_b64_tr_b16 a[20:21], v35 offset:2048
    buffer_load_dword a254, v239, s[56:59], s31 offen offset:512 sc1
    ds_read_b64_tr_b16 a[22:23], v35 offset:2560
    ds_read_b64_tr_b16 a[24:25], v34 offset:4096
    ds_read_b64_tr_b16 a[26:27], v34 offset:4608
    ds_read_b64_tr_b16 a[28:29], v35 offset:4096
    buffer_load_dword a255, v239, s[56:59], s31 offen offset:768 sc1
    ds_read_b64_tr_b16 a[30:31], v35 offset:4608
    ds_read_b64_tr_b16 a[32:33], v34 offset:6144
    ds_read_b64_tr_b16 a[34:35], v34 offset:6656
    ds_read_b64_tr_b16 a[36:37], v35 offset:6144
    ds_read_b64_tr_b16 a[38:39], v35 offset:6656
    ds_read_b64_tr_b16 a[40:41], v34 offset:36864
    ds_read_b64_tr_b16 a[42:43], v34 offset:37376
    ds_read_b64_tr_b16 a[44:45], v35 offset:36864
    ds_read_b64_tr_b16 a[46:47], v35 offset:37376
    ds_read_b64_tr_b16 a[48:49], v34 offset:38912
    ds_read_b64_tr_b16 a[50:51], v34 offset:39424
    ds_read_b64_tr_b16 a[52:53], v35 offset:38912
    ds_read_b64_tr_b16 a[54:55], v35 offset:39424
    ds_read_b64_tr_b16 a[56:57], v34 offset:40960
    ds_read_b64_tr_b16 a[58:59], v34 offset:41472
    ds_read_b64_tr_b16 a[60:61], v35 offset:40960
    ds_read_b64_tr_b16 a[62:63], v35 offset:41472
    ds_read_b64_tr_b16 a[64:65], v34 offset:43008
    ds_read_b64_tr_b16 a[66:67], v34 offset:43520
    ds_read_b64_tr_b16 a[68:69], v35 offset:43008
    ds_read_b64_tr_b16 a[70:71], v35 offset:43520
    ds_read_b64_tr_b16 a[72:73], v36 offset:0
    ds_read_b64_tr_b16 a[74:75], v36 offset:512
    ds_read_b64_tr_b16 a[76:77], v37 offset:0
    ds_read_b64_tr_b16 a[78:79], v37 offset:512
    ds_read_b64_tr_b16 a[80:81], v38 offset:0
    ds_read_b64_tr_b16 a[82:83], v38 offset:512
    ds_read_b64_tr_b16 a[84:85], v39 offset:0
    ds_read_b64_tr_b16 a[86:87], v39 offset:512
    s_waitcnt vmcnt(8)
L_m_lb1:
L_m_HMdone:
    s_add_u32 s86, s21, 0x80000
    s_mov_b32 exec_hi, 0
    buffer_store_dword v179, v237, s[56:59], s86 offen sc1
    s_mov_b32 exec_hi, -1
L_m_fa:
    v_xor_b32 v155, s10, v154
    v_xor_b32_e64 v159, s10, v158
    v_xor_b32 v163, s10, v162
    v_xor_b32 v167, s10, v166
    v_cndmask_b32 v155, 0, v155, s[88:89]
    v_cndmask_b32 v159, 0, v159, s[90:91]
    v_cndmask_b32 v163, 0, v163, s[92:93]
    v_cndmask_b32 v167, 0, v167, s[94:95]
    v_or3_b32 v155, v155, v159, v163
    v_or_b32 v155, v155, v167
    v_cmp_ne_u32 vcc, 0, v155
    s_cbranch_vccz L_lbd_13
    s_mov_b32 s51, 0
L_lbl_12:
    buffer_load_dwordx4 v[152:155], v240, s[56:59], s17 offen sc1
    buffer_load_dwordx4 v[156:159], v241, s[56:59], s17 offen sc1
    buffer_load_dwordx4 v[160:163], v242, s[56:59], s17 offen sc1
    buffer_load_dwordx4 v[164:167], v243, s[56:59], s17 offen sc1
    s_waitcnt vmcnt(0)
    v_xor_b32 v155, s10, v154
    v_xor_b32 v159, s10, v158
    v_xor_b32 v163, s10, v162
    v_xor_b32_e64 v167, s10, v166
    v_cndmask_b32 v155, 0, v155, s[88:89]
    v_cndmask_b32 v159, 0, v159, s[90:91]
    v_cndmask_b32 v163, 0, v163, s[92:93]
    v_cndmask_b32 v167, 0, v167, s[94:95]
    v_or3_b32 v155, v155, v159, v163
    v_or_b32_e64 v155, v155, v167
    v_cmp_ne_u32 vcc, 0, v155
    s_add_u32 s51, s51, 1
    s_cbranch_vccz L_lbd_13
    s_cmp_le_u32 s51, 0x20000
    s_cbranch_scc1 L_lbl_12
L_lbd_13:
L_m_Sgot:
    v_cndmask_b32 v152, 0, v152, s[88:89]
    v_cndmask_b32 v153, 0, v153, s[88:89]
    v_cndmask_b32 v156, 0, v156, s[90:91]
    v_cndmask_b32 v157, 0, v157, s[90:91]
    v_cndmask_b32 v160, 0, v160, s[92:93]
    v_cndmask_b32 v161, 0, v161, s[92:93]
    v_cndmask_b32 v164, 0, v164, s[94:95]
    v_cndmask_b32 v165, 0, v165, s[94:95]
    v_fma_f32 v160, v164, v118, v160
    v_fma_f32 v161, v164, v119, v161
    v_fma_f32 v160, -v165, v119, v160
    v_fma_f32 v161, v165, v118, v161
    v_fma_f32 v156, v160, v118, v156
    v_fma_f32 v157, v160, v119, v157
    v_fma_f32 v156, -v161, v119, v156
    v_fma_f32 v157, v161, v118, v157
    v_fma_f32 v152, v156, v118, v152
    v_fma_f32 v153, v156, v119, v153
    v_fma_f32 v152, -v157, v119, v152
    v_fma_f32 v153, v157, v118, v153
    v_mul_f32 v156, v152, v120
    v_mul_f32 v157, v152, v121
    v_fma_f32 v156, -v153, v121, v156
    v_fma_f32 v157, v153, v120, v157
    v_mov_b32 v158, v156
    v_mov_b32 v159, v157
    s_nop 0
    v_permlane16_swap_b32 v156, v158
    v_permlane16_swap_b32 v157, v159
    v_add_f32 v156, v156, v158
    v_add_f32 v157, v157, v159
    v_mov_b32 v158, v156
    v_mov_b32 v159, v157
    s_nop 0
    v_permlane32_swap_b32 v156, v158
    v_permlane32_swap_b32 v157, v159
    v_add_f32_e64 v156, v156, v158
    v_add_f32 v157, v157, v159
    s_waitcnt lgkmcnt(15)
    s_cmp_eq_u32 s12, 0
    s_cbranch_scc1 L_t0_14
    v_fma_f32 v122, v156, v116, v122
    v_fma_f32 v123, v156, v117, v123
    v_fma_f32 v122, -v157, v117, v122
    v_fma_f32 v123, v157, v116, v123
    v_mov_b32_e64 v156, v122
    v_mov_b32 v157, v123
L_t0_14:
    ds_write2_b32 v232, v156, v157 offset0:32 offset1:48
    ds_read_b128 v[136:139], v235 offset:128
    ds_read_b128 v[140:143], v235 offset:192
    s_waitcnt lgkmcnt(0)
    v_pk_fma_f32 v[144:145], v[136:137], v[124:125], v[144:145]
    v_pk_fma_f32 v[146:147], v[138:139], v[126:127], v[146:147]
    v_pk_fma_f32 v[148:149], v[140:141], v[124:125], v[148:149]
    v_pk_fma_f32 v[150:151], v[142:143], v[126:127], v[150:151]
    v_pk_fma_f32 v[144:145], v[140:141], v[128:129], v[144:145] neg_lo:[0,1,0] neg_hi:[0,1,0]
    v_pk_fma_f32 v[146:147], v[142:143], v[130:131], v[146:147] neg_lo:[0,1,0] neg_hi:[0,1,0]
    v_pk_fma_f32 v[148:149], v[136:137], v[128:129], v[148:149]
    v_pk_fma_f32 v[150:151], v[138:139], v[130:131], v[150:151]
    v_pk_fma_f32 v[0:1], v[144:145], v[100:101], v[0:1]
    v_pk_fma_f32 v[2:3], v[146:147], v[102:103], v[2:3]
    v_pk_fma_f32 v[16:17], v[148:149], v[100:101], v[16:17]
    v_pk_fma_f32 v[18:19], v[150:151], v[102:103], v[18:19]
    v_pk_fma_f32 v[0:1], v[148:149], v[104:105], v[0:1] neg_lo:[0,1,0] neg_hi:[0,1,0]
    v_pk_fma_f32 v[2:3], v[150:151], v[106:107], v[2:3] neg_lo:[0,1,0] neg_hi:[0,1,0]
    v_pk_fma_f32 v[16:17], v[144:145], v[104:105], v[16:17]
    v_pk_fma_f32 v[18:19], v[146:147], v[106:107], v[18:19]
    v_pk_mul_f32 v[196:197], v[0:1], v[192:193]
    v_pk_mul_f32 v[198:199], v[2:3], v[194:195]
    v_pk_mul_f32 v[0:1], v[0:1], v[188:189]
    v_pk_mul_f32 v[2:3], v[2:3], v[190:191]
    v_pk_fma_f32 v[0:1], v[16:17], v[192:193], v[0:1] neg_lo:[0,1,0] neg_hi:[0,1,0]
    v_pk_fma_f32 v[2:3], v[18:19], v[194:195], v[2:3] neg_lo:[0,1,0] neg_hi:[0,1,0]
    v_pk_fma_f32 v[16:17], v[16:17], v[188:189], v[196:197]
    v_pk_fma_f32 v[18:19], v[18:19], v[190:191], v[198:199]
    v_pk_fma_f32 v[4:5], v[144:145], v[108:109], v[4:5]
    v_pk_fma_f32 v[6:7], v[146:147], v[110:111], v[6:7]
    v_pk_fma_f32 v[20:21], v[148:149], v[108:109], v[20:21]
    v_pk_fma_f32 v[22:23], v[150:151], v[110:111], v[22:23]
    v_pk_fma_f32 v[4:5], v[148:149], v[112:113], v[4:5] neg_lo:[0,1,0] neg_hi:[0,1,0]
    v_pk_fma_f32 v[6:7], v[150:151], v[114:115], v[6:7] neg_lo:[0,1,0] neg_hi:[0,1,0]
    v_pk_fma_f32 v[20:21], v[144:145], v[112:113], v[20:21]
    v_pk_fma_f32 v[22:23], v[146:147], v[114:115], v[22:23]
    v_pk_mul_f32 v[196:197], v[4:5], v[192:193]
    v_pk_mul_f32 v[198:199], v[6:7], v[194:195]
    v_pk_mul_f32 v[4:5], v[4:5], v[188:189]
    v_pk_mul_f32 v[6:7], v[6:7], v[190:191]
    v_pk_fma_f32 v[4:5], v[20:21], v[192:193], v[4:5] neg_lo:[0,1,0] neg_hi:[0,1,0]
    v_pk_fma_f32 v[6:7], v[22:23], v[194:195], v[6:7] neg_lo:[0,1,0] neg_hi:[0,1,0]
    v_pk_fma_f32 v[20:21], v[20:21], v[188:189], v[196:197]
    v_pk_fma_f32 v[22:23], v[22:23], v[190:191], v[198:199]
    v_cvt_pk_bf16_f32 v152, v0, v1
    v_cvt_pk_bf16_f32 v153, v2, v3
    v_cvt_pk_bf16_f32 v154, v4, v5
    v_cvt_pk_bf16_f32 v155, v6, v7
    v_cvt_pk_bf16_f32 v156, -v16, -v17
    v_cvt_pk_bf16_f32 v157, -v18, -v19
    v_cvt_pk_bf16_f32 v158, -v20, -v21
    v_cvt_pk_bf16_f32 v159, -v22, -v23
    v_permlane16_swap_b32 v152, v154
    v_permlane16_swap_b32 v153, v155
    buffer_store_dwordx4 v[152:155], v254, s[56:59], s20 offen offset:0 sc1
    v_permlane16_swap_b32 v156, v158
    v_permlane16_swap_b32 v157, v159
    buffer_store_dwordx4 v[156:159], v254, s[56:59], s20 offen offset:2048 sc1
    v_pk_fma_f32 v[8:9], v[144:145], v[80:81], v[8:9]
    v_pk_fma_f32 v[10:11], v[146:147], v[82:83], v[10:11]
    v_pk_fma_f32 v[24:25], v[148:149], v[80:81], v[24:25]
    v_pk_fma_f32 v[26:27], v[150:151], v[82:83], v[26:27]
    v_pk_fma_f32 v[8:9], v[148:149], v[84:85], v[8:9] neg_lo:[0,1,0] neg_hi:[0,1,0]
    v_pk_fma_f32 v[10:11], v[150:151], v[86:87], v[10:11] neg_lo:[0,1,0] neg_hi:[0,1,0]
    v_pk_fma_f32 v[24:25], v[144:145], v[84:85], v[24:25]
    v_pk_fma_f32 v[26:27], v[146:147], v[86:87], v[26:27]
    v_pk_mul_f32 v[196:197], v[8:9], v[192:193]
    v_pk_mul_f32 v[198:199], v[10:11], v[194:195]
    v_pk_mul_f32 v[8:9], v[8:9], v[188:189]
    v_pk_mul_f32 v[10:11], v[10:11], v[190:191]
    v_pk_fma_f32 v[8:9], v[24:25], v[192:193], v[8:9] neg_lo:[0,1,0] neg_hi:[0,1,0]
    v_pk_fma_f32 v[10:11], v[26:27], v[194:195], v[10:11] neg_lo:[0,1,0] neg_hi:[0,1,0]
    v_pk_fma_f32 v[24:25], v[24:25], v[188:189], v[196:197]
    v_pk_fma_f32 v[26:27], v[26:27], v[190:191], v[198:199]
    v_pk_fma_f32 v[12:13], v[144:145], v[88:89], v[12:13]
    v_pk_fma_f32 v[14:15], v[146:147], v[90:91], v[14:15]
    v_pk_fma_f32 v[28:29], v[148:149], v[88:89], v[28:29]
    v_pk_fma_f32 v[30:31], v[150:151], v[90:91], v[30:31]
    v_pk_fma_f32 v[12:13], v[148:149], v[92:93], v[12:13] neg_lo:[0,1,0] neg_hi:[0,1,0]
    v_pk_fma_f32 v[14:15], v[150:151], v[94:95], v[14:15] neg_lo:[0,1,0] neg_hi:[0,1,0]
    v_pk_fma_f32 v[28:29], v[144:145], v[92:93], v[28:29]
    v_pk_fma_f32 v[30:31], v[146:147], v[94:95], v[30:31]
    v_pk_mul_f32 v[196:197], v[12:13], v[192:193]
    v_pk_mul_f32 v[198:199], v[14:15], v[194:195]
    v_pk_mul_f32 v[12:13], v[12:13], v[188:189]
    v_pk_mul_f32 v[14:15], v[14:15], v[190:191]
    v_pk_fma_f32 v[12:13], v[28:29], v[192:193], v[12:13] neg_lo:[0,1,0] neg_hi:[0,1,0]
    v_pk_fma_f32 v[14:15], v[30:31], v[194:195], v[14:15] neg_lo:[0,1,0] neg_hi:[0,1,0]
    v_pk_fma_f32 v[28:29], v[28:29], v[188:189], v[196:197]
    v_pk_fma_f32 v[30:31], v[30:31], v[190:191], v[198:199]
    v_cvt_pk_bf16_f32 v160, v8, v9
    v_cvt_pk_bf16_f32 v161, v10, v11
    v_cvt_pk_bf16_f32 v162, v12, v13
    v_cvt_pk_bf16_f32 v163, v14, v15
    v_cvt_pk_bf16_f32 v164, -v24, -v25
    v_cvt_pk_bf16_f32 v165, -v26, -v27
    v_cvt_pk_bf16_f32 v166, -v28, -v29
    v_cvt_pk_bf16_f32 v167, -v30, -v31
    v_permlane16_swap_b32 v160, v162
    v_permlane16_swap_b32 v161, v163
    buffer_store_dwordx4 v[160:163], v254, s[56:59], s20 offen offset:1024 sc1
    v_permlane16_swap_b32 v164, v166
    v_permlane16_swap_b32 v165, v167
L_stub_2:
    s_cbranch_execz L_back
    buffer_store_dwordx4 v[164:167], v254, s[56:59], s20 offen offset:3072 sc1
L_m_epi:
    s_lshr_b32 s86, s82, 14
    s_lshl_b32 s86, s86, 11
    s_add_u32 s86, s86, 0x800000
    s_lshl2_add_u32 s34, s7, s4
    s_lshl_b32 s34, s34, 14
    s_add_u32 s34, s34, 0x82c000
    s_lshl1_add_u32 s87, s5, s7
    s_mul_i32 s35, s87, 311296
    s_add_u32 s25, s35, s86
    s_add_u32 s36, s35, s34
    s_xor_b32 s35, s87, 1
    s_mul_i32 s35, s35, 311296
    s_add_u32 s24, s35, s86
    s_add_u32 s33, s35, s34
    s_lshl1_add_u32 s22, s87, s12
    s_lshl4_add_u32 s22, s22, s13
    s_lshl_b32 s22, s22, 7
    s_add_u32 s22, s22, 0x80000
    s_lshl2_add_u32 s23, s87, s4
    s_lshl_b32 s23, s23, 10
    s_add_u32 s23, s23, 0xa0000
    s_lshl_b32 s32, s11, 11
    s_add_u32 s32, s32, 0x100000
    v_and_b32 v236, 7, v255
    v_lshlrev_b32 v236, 8, v236
    v_lshrrev_b32 v235, 3, v253
    v_lshlrev_b32_e64 v235, 12, v235
    v_lshl_add_u32 v235, v250, 8, v235
    v_and_b32 v233, 0x17, v255
    v_and_b32 v234, 7, v255
    v_add_u32 v233, v233, v234
    v_lshl_add_u32 v235, v233, 3, v235
    s_lshl_b32 s86, s4, 9
    v_add_u32 v235, s86, v235
    v_add_u32 v233, 0x10000, v235
    s_lshl_b32 m0, s4, 14
    s_mov_b32 s83, 0x10001
    s_mul_i32 s86, s10, 0x9e3779b1
    v_and_b32 v240, 3, v255
    v_lshlrev_b32 v240, 3, v240
    v_lshrrev_b32 v240, v240, s86
    v_and_b32 v240, 0xff, v240
    v_lshl_or_b32 v240, v240, 12, v240
    v_lshrrev_b32 v243, 3, v240
    v_lshrrev_b32 v242, 2, v240
    v_lshrrev_b32 v241, 1, v240
    v_and_b32 v240, s83, v240
    v_and_b32 v241, s83, v241
    v_and_b32 v242, s83, v242
    v_and_b32 v243, s83, v243
    s_waitcnt vmcnt(5)
    v_accvgpr_read_b32 v128, a240
    v_accvgpr_read_b32 v129, a241
    v_accvgpr_read_b32 v130, a242
    v_accvgpr_read_b32 v131, a243
    v_accvgpr_read_b32 v132, a244
    v_accvgpr_read_b32 v133, a245
    v_accvgpr_read_b32 v134, a246
    v_accvgpr_read_b32 v135, a247
    v_accvgpr_read_b32 v140, a248
    v_accvgpr_read_b32 v141, a249
    v_accvgpr_read_b32 v142, a250
    v_accvgpr_read_b32 v143, a251
    v_accvgpr_read_b32 v136, a252
    v_accvgpr_read_b32 v137, a253
    v_accvgpr_read_b32 v138, a254
    v_accvgpr_read_b32 v139, a255
    v_lshlrev_b32_e64 v144, 16, v140
    v_and_b32 v145, 0xffff0000, v140
    v_lshlrev_b32_e64 v146, 16, v141
    v_and_b32 v147, 0xffff0000, v141
    v_lshlrev_b32_e64 v148, 16, v142
    v_and_b32 v149, 0xffff0000, v142
    v_lshlrev_b32_e64 v150, 16, v143
    v_and_b32 v151, 0xffff0000, v143
    v_and_b32 v157, 0xffff0000, v136
    v_lshlrev_b32_e64 v156, 16, v136
    v_rcp_f32 v157, v157
    v_lshlrev_b32 v192, 16, v128
    v_and_b32 v193, 0xffff0000, v128
    v_lshlrev_b32_e64 v194, 16, v129
    v_and_b32 v195, 0xffff0000, v129
    v_pk_add_f32 v[152:153], v[192:193], v[156:157] op_sel:[0,0] op_sel_hi:[1,0] neg_lo:[0,1] neg_hi:[0,1]
    v_pk_add_f32 v[154:155], v[194:195], v[156:157] op_sel:[0,0] op_sel_hi:[1,0] neg_lo:[0,1] neg_hi:[0,1]
    v_cvt_pk_bf16_f32 v153, v152, v153
    v_cvt_pk_bf16_f32 v155, v154, v155
    v_lshlrev_b32 v152, 16, v153
    v_lshlrev_b32 v154, 16, v155
    v_and_b32 v153, 0xffff0000, v153
    v_and_b32 v155, 0xffff0000, v155
    v_pk_mul_f32 v[152:153], v[152:153], v[156:157] op_sel:[0,1] op_sel_hi:[1,1]
    v_pk_mul_f32 v[154:155], v[154:155], v[156:157] op_sel:[0,1] op_sel_hi:[1,1]
    v_cvt_pk_bf16_f32 v153, v152, v153
    v_cvt_pk_bf16_f32 v155, v154, v155
    v_lshlrev_b32 v152, 16, v153
    v_lshlrev_b32 v154, 16, v155
    v_and_b32 v153, 0xffff0000, v153
    v_and_b32 v155, 0xffff0000, v155
    v_pk_mul_f32 v[152:153], v[152:153], v[144:145]
    v_pk_mul_f32 v[154:155], v[154:155], v[146:147]
    v_cvt_pk_bf16_f32 v153, v152, v153
    v_cvt_pk_bf16_f32 v155, v154, v155
    v_lshlrev_b32 v152, 16, v153
    v_lshlrev_b32 v154, 16, v155
    v_and_b32 v153, 0xffff0000, v153
    v_and_b32 v155, 0xffff0000, v155
    v_pk_add_f32 v[192:193], v[192:193], v[152:153]
    v_pk_add_f32 v[194:195], v[194:195], v[154:155]
    v_pk_add_f32 v[192:193], v[192:193], v[148:149]
    v_pk_add_f32 v[194:195], v[194:195], v[150:151]
    v_and_b32 v157, 0xffff0000, v137
    v_lshlrev_b32_e64 v156, 16, v137
    v_rcp_f32 v157, v157
    v_lshlrev_b32 v196, 16, v130
    v_and_b32 v197, 0xffff0000, v130
    v_lshlrev_b32_e64 v198, 16, v131
    v_and_b32 v199, 0xffff0000, v131
    v_pk_add_f32 v[152:153], v[196:197], v[156:157] op_sel:[0,0] op_sel_hi:[1,0] neg_lo:[0,1] neg_hi:[0,1]
    v_pk_add_f32 v[154:155], v[198:199], v[156:157] op_sel:[0,0] op_sel_hi:[1,0] neg_lo:[0,1] neg_hi:[0,1]
    v_cvt_pk_bf16_f32 v153, v152, v153
    v_cvt_pk_bf16_f32 v155, v154, v155
    v_lshlrev_b32 v152, 16, v153
    v_lshlrev_b32 v154, 16, v155
    v_and_b32 v153, 0xffff0000, v153
    v_and_b32 v155, 0xffff0000, v155
    v_pk_mul_f32 v[152:153], v[152:153], v[156:157] op_sel:[0,1] op_sel_hi:[1,1]
    v_pk_mul_f32 v[154:155], v[154:155], v[156:157] op_sel:[0,1] op_sel_hi:[1,1]
    v_cvt_pk_bf16_f32 v153, v152, v153
    v_cvt_pk_bf16_f32 v155, v154, v155
    v_lshlrev_b32 v152, 16, v153
    v_lshlrev_b32 v154, 16, v155
    v_and_b32 v153, 0xffff0000, v153
    v_and_b32 v155, 0xffff0000, v155
    v_pk_mul_f32 v[152:153], v[152:153], v[144:145]
    v_pk_mul_f32 v[154:155], v[154:155], v[146:147]
    v_cvt_pk_bf16_f32 v153, v152, v153
    v_cvt_pk_bf16_f32 v155, v154, v155
    v_lshlrev_b32 v152, 16, v153
    v_lshlrev_b32 v154, 16, v155
    v_and_b32 v153, 0xffff0000, v153
    v_and_b32 v155, 0xffff0000, v155
    v_pk_add_f32 v[196:197], v[196:197], v[152:153]
    v_pk_add_f32 v[198:199], v[198:199], v[154:155]
    v_pk_add_f32 v[196:197], v[196:197], v[148:149]
    v_pk_add_f32 v[198:199], v[198:199], v[150:151]
    v_and_b32 v157, 0xffff0000, v138
    v_lshlrev_b32_e64 v156, 16, v138
    v_rcp_f32 v157, v157
    v_lshlrev_b32 v200, 16, v132
    v_and_b32 v201, 0xffff0000, v132
    v_lshlrev_b32_e64 v202, 16, v133
    v_and_b32 v203, 0xffff0000, v133
    v_pk_add_f32 v[152:153], v[200:201], v[156:157] op_sel:[0,0] op_sel_hi:[1,0] neg_lo:[0,1] neg_hi:[0,1]
    v_pk_add_f32 v[154:155], v[202:203], v[156:157] op_sel:[0,0] op_sel_hi:[1,0] neg_lo:[0,1] neg_hi:[0,1]
    v_cvt_pk_bf16_f32 v153, v152, v153
    v_cvt_pk_bf16_f32 v155, v154, v155
    v_lshlrev_b32 v152, 16, v153
    v_lshlrev_b32 v154, 16, v155
    v_and_b32 v153, 0xffff0000, v153
    v_and_b32 v155, 0xffff0000, v155
    v_pk_mul_f32 v[152:153], v[152:153], v[156:157] op_sel:[0,1] op_sel_hi:[1,1]
    v_pk_mul_f32 v[154:155], v[154:155], v[156:157] op_sel:[0,1] op_sel_hi:[1,1]
    v_cvt_pk_bf16_f32 v153, v152, v153
    v_cvt_pk_bf16_f32 v155, v154, v155
    v_lshlrev_b32 v152, 16, v153
    v_lshlrev_b32 v154, 16, v155
    v_and_b32 v153, 0xffff0000, v153
    v_and_b32 v155, 0xffff0000, v155
    v_pk_mul_f32 v[152:153], v[152:153], v[144:145]
    v_pk_mul_f32 v[154:155], v[154:155], v[146:147]
    v_cvt_pk_bf16_f32 v153, v152, v153
    v_cvt_pk_bf16_f32 v155, v154, v155
    v_lshlrev_b32 v152, 16, v153
    v_lshlrev_b32 v154, 16, v155
    v_and_b32 v153, 0xffff0000, v153
    v_and_b32 v155, 0xffff0000, v155
    v_pk_add_f32 v[200:201], v[200:201], v[152:153]
    v_pk_add_f32 v[202:203], v[202:203], v[154:155]
    v_pk_add_f32 v[200:201], v[200:201], v[148:149]
    v_pk_add_f32 v[202:203], v[202:203], v[150:151]
    buffer_load_dword v244, v236, s[56:59], s22 offen sc1
    v_and_b32 v157, 0xffff0000, v139
    v_lshlrev_b32_e64 v156, 16, v139
    v_rcp_f32 v157, v157
    v_lshlrev_b32 v204, 16, v134
    v_and_b32 v205, 0xffff0000, v134
    v_lshlrev_b32_e64 v206, 16, v135
    v_and_b32 v207, 0xffff0000, v135
    v_pk_add_f32 v[152:153], v[204:205], v[156:157] op_sel:[0,0] op_sel_hi:[1,0] neg_lo:[0,1] neg_hi:[0,1]
    v_pk_add_f32 v[154:155], v[206:207], v[156:157] op_sel:[0,0] op_sel_hi:[1,0] neg_lo:[0,1] neg_hi:[0,1]
    v_cvt_pk_bf16_f32 v153, v152, v153
    v_cvt_pk_bf16_f32 v155, v154, v155
    v_lshlrev_b32 v152, 16, v153
    v_lshlrev_b32 v154, 16, v155
    v_and_b32 v153, 0xffff0000, v153
    v_and_b32 v155, 0xffff0000, v155
    v_pk_mul_f32 v[152:153], v[152:153], v[156:157] op_sel:[0,1] op_sel_hi:[1,1]
    v_pk_mul_f32 v[154:155], v[154:155], v[156:157] op_sel:[0,1] op_sel_hi:[1,1]
    v_cvt_pk_bf16_f32 v153, v152, v153
    v_cvt_pk_bf16_f32 v155, v154, v155
    v_lshlrev_b32 v152, 16, v153
    v_lshlrev_b32 v154, 16, v155
    v_and_b32 v153, 0xffff0000, v153
    v_and_b32 v155, 0xffff0000, v155
    v_pk_mul_f32 v[152:153], v[152:153], v[144:145]
    v_pk_mul_f32 v[154:155], v[154:155], v[146:147]
    v_cvt_pk_bf16_f32 v153, v152, v153
    v_cvt_pk_bf16_f32 v155, v154, v155
    v_lshlrev_b32 v152, 16, v153
    v_lshlrev_b32 v154, 16, v155
    v_and_b32 v153, 0xffff0000, v153
    v_and_b32 v155, 0xffff0000, v155
    v_pk_add_f32 v[204:205], v[204:205], v[152:153]
    v_pk_add_f32 v[206:207], v[206:207], v[154:155]
    v_pk_add_f32 v[204:205], v[204:205], v[148:149]
    v_pk_add_f32 v[206:207], v[206:207], v[150:151]
    v_lshlrev_b32_e64 v239, 1, v238
L_m_res:
    s_waitcnt vmcnt(1)
L_m_HSdone:
    s_add_u32 s86, s21, 0xa0000
    s_mov_b32 exec_hi, 0
    buffer_store_dword v179, v237, s[56:59], s86 offen sc1
    s_mov_b32 exec_hi, -1
L_m_fb:
    s_waitcnt vmcnt(1)
L_m_pa1:
    v_cmp_ne_u32 vcc, s10, v244
    s_cbranch_vccz L_pad_16
    s_mov_b32 s51, 0
L_pal_15:
    buffer_load_dword v244, v236, s[56:59], s22 offen sc1
    s_waitcnt vmcnt(0)
    v_cmp_ne_u32 vcc, s10, v244
    s_add_u32 s51, s51, 1
    s_cbranch_vccz L_pad_16
    s_cmp_le_u32 s51, 0x20000
    s_cbranch_scc1 L_pal_15
L_pad_16:
L_m_paok:
    buffer_load_dwordx4 a[152:155], v254, s[56:59], s24 offen offset:0 sc1
    buffer_load_dwordx4 a[156:159], v254, s[56:59], s24 offen offset:1024 sc1
    s_add_u32 s37, s24, 12288
    buffer_load_dwordx4 a[160:163], v254, s[56:59], s37 offen offset:0 sc1
    buffer_load_dwordx4 a[164:167], v254, s[56:59], s37 offen offset:1024 sc1
    s_add_u32 s37, s24, 24576
    buffer_load_dwordx4 a[168:171], v254, s[56:59], s37 offen offset:0 sc1
    buffer_load_dwordx4 a[172:175], v254, s[56:59], s37 offen offset:1024 sc1
    s_add_u32 s37, s24, 36864
    buffer_load_dwordx4 a[176:179], v254, s[56:59], s37 offen offset:0 sc1
    buffer_load_dwordx4 a[180:183], v254, s[56:59], s37 offen offset:1024 sc1
    s_add_u32 s37, s24, 4096
    buffer_load_dwordx4 a[184:187], v254, s[56:59], s37 offen offset:0 sc1
    buffer_load_dwordx4 a[188:191], v254, s[56:59], s37 offen offset:1024 sc1
    ds_read_b128 a[88:91], v40 offset:0
    ds_read_b128 a[92:95], v40 offset:4096
    ds_read_b128 a[104:107], v41 offset:0
    ds_read_b128 a[108:111], v41 offset:4096
    ds_read_b128 a[120:123], v42 offset:0
    ds_read_b128 a[124:127], v42 offset:4096
    ds_read_b128 a[136:139], v43 offset:0
    ds_read_b128 a[140:143], v43 offset:4096
    ds_read_b128 a[96:99], v40 offset:36864
    ds_read_b128 a[100:103], v40 offset:40960
    ds_read_b128 a[112:115], v41 offset:36864
    ds_read_b128 a[116:119], v41 offset:40960
    ds_read_b128 a[128:131], v42 offset:36864
    ds_read_b128 a[132:135], v42 offset:40960
    ds_read_b128 a[144:147], v43 offset:36864
    ds_read_b128 a[148:151], v43 offset:40960
    s_waitcnt lgkmcnt(0)
    v_lshrrev_b32 v236, 1, v236
    s_waitcnt vmcnt(9)
L_m_h0:
    v_mfma_f32_32x32x16_bf16 v[0:15], a[152:155], a[0:3], 0
    s_add_u32 s37, s24, 16384
    buffer_load_dwordx4 a[192:195], v254, s[56:59], s37 offen offset:0 sc1
    v_mfma_f32_32x32x16_bf16 v[16:31], a[152:155], a[4:7], 0
    buffer_load_dwordx4 a[196:199], v254, s[56:59], s37 offen offset:1024 sc1
    s_waitcnt vmcnt(10)
    v_mfma_f32_32x32x16_bf16 v[32:47], a[156:159], a[0:3], 0
    s_add_u32 s37, s24, 28672
    buffer_load_dwordx4 a[200:203], v254, s[56:59], s37 offen offset:0 sc1
    v_mfma_f32_32x32x16_bf16 v[48:63], a[156:159], a[4:7], 0
    buffer_load_dwordx4 a[204:207], v254, s[56:59], s37 offen offset:1024 sc1
    s_waitcnt vmcnt(11)
    v_mfma_f32_32x32x16_bf16 v[0:15], a[160:163], a[8:11], v[0:15]
    s_add_u32 s37, s24, 40960
    buffer_load_dwordx4 a[208:211], v254, s[56:59], s37 offen offset:0 sc1
    v_mfma_f32_32x32x16_bf16 v[16:31], a[160:163], a[12:15], v[16:31]
    buffer_load_dwordx4 a[212:215], v254, s[56:59], s37 offen offset:1024 sc1
    s_waitcnt vmcnt(12)
    v_mfma_f32_32x32x16_bf16 v[32:47], a[164:167], a[8:11], v[32:47]
    s_add_u32 s37, s24, 8192
    buffer_load_dwordx4 a[216:219], v254, s[56:59], s37 offen offset:0 sc1
    v_mfma_f32_32x32x16_bf16 v[48:63], a[164:167], a[12:15], v[48:63]
    buffer_load_dwordx4 a[220:223], v254, s[56:59], s37 offen offset:1024 sc1
    s_waitcnt vmcnt(13)
    v_mfma_f32_32x32x16_bf16 v[0:15], a[168:171], a[16:19], v[0:15]
    s_add_u32 s37, s24, 20480
    buffer_load_dwordx4 a[224:227], v254, s[56:59], s37 offen offset:0 sc1
    v_mfma_f32_32x32x16_bf16 v[16:31], a[168:171], a[20:23], v[16:31]
    s_waitcnt vmcnt(13)
    v_mfma_f32_32x32x16_bf16 v[32:47], a[172:175], a[16:19], v[32:47]
    buffer_load_dwordx4 a[228:231], v254, s[56:59], s37 offen offset:1024 sc1
    v_mfma_f32_32x32x16_bf16 v[48:63], a[172:175], a[20:23], v[48:63]
    s_waitcnt vmcnt(13)
    v_mfma_f32_32x32x16_bf16 v[0:15], a[176:179], a[24:27], v[0:15]
    s_add_u32 s37, s24, 32768
    buffer_load_dwordx4 a[232:235], v254, s[56:59], s37 offen offset:0 sc1
    v_mfma_f32_32x32x16_bf16 v[16:31], a[176:179], a[28:31], v[16:31]
    s_waitcnt vmcnt(13)
    v_mfma_f32_32x32x16_bf16 v[32:47], a[180:183], a[24:27], v[32:47]
    buffer_load_dwordx4 a[236:239], v254, s[56:59], s37 offen offset:1024 sc1
    v_mfma_f32_32x32x16_bf16 v[48:63], a[180:183], a[28:31], v[48:63]
    buffer_load_dword v244, v236, s[56:59], s23 offen sc1
    buffer_load_dwordx4 a[152:155], v254, s[56:59], s25 offen offset:0 sc1
    s_waitcnt vmcnt(15)
    v_mfma_f32_32x32x16_bf16 v[0:15], a[184:187], a[32:35], v[0:15]
    v_mfma_f32_32x32x16_bf16 v[16:31], a[184:187], a[36:39], v[16:31]
    buffer_load_dwordx4 a[156:159], v254, s[56:59], s25 offen offset:1024 sc1
    s_waitcnt vmcnt(15)
    v_mfma_f32_32x32x16_bf16 v[32:47], a[188:191], a[32:35], v[32:47]
    v_mfma_f32_32x32x16_bf16 v[48:63], a[188:191], a[36:39], v[48:63]
    s_add_u32 s37, s25, 12288
    buffer_load_dwordx4 a[160:163], v254, s[56:59], s37 offen offset:0 sc1
    s_waitcnt vmcnt(15)
    v_mfma_f32_32x32x16_bf16 v[0:15], a[192:195], a[40:43], v[0:15]
    v_mfma_f32_32x32x16_bf16 v[16:31], a[192:195], a[44:47], v[16:31]
    buffer_load_dwordx4 a[164:167], v254, s[56:59], s37 offen offset:1024 sc1
    s_waitcnt vmcnt(15)
    v_mfma_f32_32x32x16_bf16 v[32:47], a[196:199], a[40:43], v[32:47]
    v_mfma_f32_32x32x16_bf16 v[48:63], a[196:199], a[44:47], v[48:63]
    s_add_u32 s37, s25, 24576
    buffer_load_dwordx4 a[168:171], v254, s[56:59], s37 offen offset:0 sc1
    s_waitcnt vmcnt(15)
L_m_h6:
    v_mfma_f32_32x32x16_bf16 v[0:15], a[200:203], a[48:51], v[0:15]
    v_mfma_f32_32x32x16_bf16 v[16:31], a[200:203], a[52:55], v[16:31]
    buffer_load_dwordx4 a[172:175], v254, s[56:59], s37 offen offset:1024 sc1
    s_waitcnt vmcnt(15)
    v_mfma_f32_32x32x16_bf16 v[32:47], a[204:207], a[48:51], v[32:47]
    v_mfma_f32_32x32x16_bf16 v[48:63], a[204:207], a[52:55], v[48:63]
    s_add_u32 s37, s25, 36864
    buffer_load_dwordx4 a[176:179], v254, s[56:59], s37 offen offset:0 sc1
    s_waitcnt vmcnt(15)
    v_mfma_f32_32x32x16_bf16 v[0:15], a[208:211], a[56:59], v[0:15]
    v_mfma_f32_32x32x16_bf16 v[16:31], a[208:211], a[60:63], v[16:31]
    buffer_load_dwordx4 a[180:183], v254, s[56:59], s37 offen offset:1024 sc1
    s_waitcnt vmcnt(15)
    v_mfma_f32_32x32x16_bf16 v[32:47], a[212:215], a[56:59], v[32:47]
    s_waitcnt vmcnt(8)
    v_cmp_ne_u32 vcc, s10, v244
    s_cbranch_vccz L_pbd_18
    s_mov_b32 s51, 0
L_pbl_17:
    buffer_load_dword v244, v236, s[56:59], s23 offen sc1
    s_waitcnt vmcnt(0)
    v_cmp_ne_u32 vcc, s10, v244
    s_add_u32 s51, s51, 1
    s_cbranch_vccz L_pbd_18
    s_cmp_le_u32 s51, 0x20000
    s_cbranch_scc1 L_pbl_17
L_pbd_18:
L_m_pbok:
    buffer_load_dwordx4 a[184:187], v254, s[56:59], s33 offen offset:0 sc1
    v_mfma_f32_32x32x16_bf16 v[48:63], a[212:215], a[60:63], v[48:63]
    s_barrier
    v_mfma_f32_32x32x16_bf16 v[0:15], a[216:219], a[64:67], v[0:15]
    buffer_load_dwordx4 a[188:191], v254, s[56:59], s33 offen offset:1024 sc1
    v_mfma_f32_32x32x16_bf16 v[16:31], a[216:219], a[68:71], v[16:31]
    v_mfma_f32_32x32x16_bf16 v[32:47], a[220:223], a[64:67], v[32:47]
    buffer_load_dwordx4 a[192:195], v254, s[56:59], s33 offen offset:2048 sc1
    v_mfma_f32_32x32x16_bf16 v[48:63], a[220:223], a[68:71], v[48:63]
    v_mfma_f32_32x32x16_bf16 v[0:15], a[224:227], a[72:75], v[0:15]
    buffer_load_dwordx4 a[196:199], v254, s[56:59], s33 offen offset:3072 sc1
    v_mfma_f32_32x32x16_bf16 v[16:31], a[224:227], a[76:79], v[16:31]
    v_mfma_f32_32x32x16_bf16 v[32:47], a[228:231], a[72:75], v[32:47]
    s_add_u32 s37, s33, 4096
    buffer_load_dwordx4 a[200:203], v254, s[56:59], s37 offen offset:0 sc1
    v_mfma_f32_32x32x16_bf16 v[48:63], a[228:231], a[76:79], v[48:63]
    v_mfma_f32_32x32x16_bf16 v[0:15], a[232:235], a[80:83], v[0:15]
    buffer_load_dwordx4 a[204:207], v254, s[56:59], s37 offen offset:2048 sc1
    v_mfma_f32_32x32x16_bf16 v[16:31], a[232:235], a[84:87], v[16:31]
    v_mfma_f32_32x32x16_bf16 v[32:47], a[236:239], a[80:83], v[32:47]
    s_add_u32 s37, s33, 8192
    buffer_load_dwordx4 a[208:211], v254, s[56:59], s37 offen offset:0 sc1
    v_mfma_f32_32x32x16_bf16 v[48:63], a[236:239], a[84:87], v[48:63]
    s_waitcnt vmcnt(14)
    s_nop 0
    v_mfma_f32_32x32x16_bf16 v[64:79], a[152:155], a[0:3], 0
    buffer_load_dwordx4 a[212:215], v254, s[56:59], s37 offen offset:2048 sc1
    v_mfma_f32_32x32x16_bf16 v[80:95], a[152:155], a[4:7], 0
    s_add_u32 s37, s33, 12288
    buffer_load_dwordx4 a[216:219], v254, s[56:59], s37 offen offset:0 sc1
    s_waitcnt vmcnt(15)
    v_mfma_f32_32x32x16_bf16 v[96:111], a[156:159], a[0:3], 0
    v_mfma_f32_32x32x16_bf16 v[112:127], a[156:159], a[4:7], 0
    buffer_load_dwordx4 a[220:223], v254, s[56:59], s37 offen offset:2048 sc1
    s_waitcnt vmcnt(15)
L_m_h12:
    v_mfma_f32_32x32x16_bf16 v[64:79], a[160:163], a[8:11], v[64:79]
    v_mfma_f32_32x32x16_bf16 v[80:95], a[160:163], a[12:15], v[80:95]
    s_add_u32 s37, s33, 5120
    buffer_load_dwordx4 a[224:227], v254, s[56:59], s37 offen offset:0 sc1
    s_waitcnt vmcnt(15)
    v_mfma_f32_32x32x16_bf16 v[96:111], a[164:167], a[8:11], v[96:111]
    v_mfma_f32_32x32x16_bf16 v[112:127], a[164:167], a[12:15], v[112:127]
    buffer_load_dwordx4 a[228:231], v254, s[56:59], s37 offen offset:2048 sc1
    s_waitcnt vmcnt(15)
    v_mfma_f32_32x32x16_bf16 v[64:79], a[168:171], a[16:19], v[64:79]
    v_mfma_f32_32x32x16_bf16 v[80:95], a[168:171], a[20:23], v[80:95]
    s_add_u32 s37, s33, 9216
    buffer_load_dwordx4 a[232:235], v254, s[56:59], s37 offen offset:0 sc1
    s_waitcnt vmcnt(15)
    v_mfma_f32_32x32x16_bf16 v[96:111], a[172:175], a[16:19], v[96:111]
    v_mfma_f32_32x32x16_bf16 v[112:127], a[172:175], a[20:23], v[112:127]
    buffer_load_dwordx4 a[236:239], v254, s[56:59], s37 offen offset:2048 sc1
    s_waitcnt vmcnt(15)
    v_mfma_f32_32x32x16_bf16 v[64:79], a[176:179], a[24:27], v[64:79]
    v_mfma_f32_32x32x16_bf16 v[80:95], a[176:179], a[28:31], v[80:95]
    s_add_u32 s37, s33, 13312
    buffer_load_dwordx4 a[152:155], v254, s[56:59], s37 offen offset:0 sc1
    s_waitcnt vmcnt(15)
    v_mfma_f32_32x32x16_bf16 v[96:111], a[180:183], a[24:27], v[96:111]
    v_mfma_f32_32x32x16_bf16 v[112:127], a[180:183], a[28:31], v[112:127]
    buffer_load_dwordx4 a[156:159], v254, s[56:59], s37 offen offset:2048 sc1
    s_waitcnt vmcnt(15)
    v_mfma_f32_32x32x16_bf16 v[0:15], a[184:187], a[88:91], v[0:15]
    s_add_u32 s37, s25, 4096
    buffer_load_dwordx4 a[160:163], v254, s[56:59], s37 offen offset:0 sc1
    v_mfma_f32_32x32x16_bf16 v[16:31], a[184:187], a[92:95], v[16:31]
    s_waitcnt vmcnt(15)
    v_mfma_f32_32x32x16_bf16 v[32:47], a[188:191], a[88:91], v[32:47]
    buffer_load_dwordx4 a[164:167], v254, s[56:59], s37 offen offset:1024 sc1
    v_mfma_f32_32x32x16_bf16 v[48:63], a[188:191], a[92:95], v[48:63]
    s_waitcnt vmcnt(15)
    v_mfma_f32_32x32x16_bf16 v[0:15], a[192:195], a[96:99], v[0:15]
    s_add_u32 s37, s25, 16384
    buffer_load_dwordx4 a[168:171], v254, s[56:59], s37 offen offset:0 sc1
    v_mfma_f32_32x32x16_bf16 v[16:31], a[192:195], a[100:103], v[16:31]
    s_waitcnt vmcnt(15)
    v_mfma_f32_32x32x16_bf16 v[32:47], a[196:199], a[96:99], v[32:47]
    buffer_load_dwordx4 a[172:175], v254, s[56:59], s37 offen offset:1024 sc1
    v_mfma_f32_32x32x16_bf16 v[48:63], a[196:199], a[100:103], v[48:63]
    s_waitcnt vmcnt(15)
    v_mfma_f32_32x32x16_bf16 v[0:15], a[200:203], a[104:107], v[0:15]
    s_add_u32 s37, s25, 28672
    buffer_load_dwordx4 a[176:179], v254, s[56:59], s37 offen offset:0 sc1
    s_waitcnt vmcnt(15)
    v_mfma_f32_32x32x16_bf16 v[0:15], a[204:207], a[112:115], v[0:15]
    s_waitcnt vmcnt(14)
    v_mfma_f32_32x32x16_bf16 v[0:15], a[208:211], a[120:123], v[0:15]
    buffer_load_dwordx4 a[180:183], v254, s[56:59], s37 offen offset:1024 sc1
    s_waitcnt vmcnt(14)
    v_mfma_f32_32x32x16_bf16 v[0:15], a[212:215], a[128:131], v[0:15]
    s_waitcnt vmcnt(13)
    v_mfma_f32_32x32x16_bf16 v[0:15], a[216:219], a[136:139], v[0:15]
    s_add_u32 s37, s25, 40960
    buffer_load_dwordx4 a[184:187], v254, s[56:59], s37 offen offset:0 sc1
    s_waitcnt vmcnt(13)
    v_mfma_f32_32x32x16_bf16 v[0:15], a[220:223], a[144:147], v[0:15]
    v_mfma_f32_32x32x16_bf16 v[16:31], a[200:203], a[108:111], v[16:31]
    buffer_load_dwordx4 a[188:191], v254, s[56:59], s37 offen offset:1024 sc1
    v_mfma_f32_32x32x16_bf16 v[16:31], a[204:207], a[116:119], v[16:31]
    s_add_u32 s37, s25, 8192
    buffer_load_dwordx4 a[192:195], v254, s[56:59], s37 offen offset:0 sc1
    s_nop 6
    ds_write_addtid_b32 v0 offset:0
    ds_write_addtid_b32 v1 offset:256
L_m_h19:
    v_mfma_f32_32x32x16_bf16 v[16:31], a[208:211], a[124:127], v[16:31]
    ds_write_addtid_b32 v2 offset:512
    ds_write_addtid_b32 v3 offset:768
    ds_write_addtid_b32 v4 offset:1024
    ds_write_addtid_b32 v5 offset:1280
    v_mfma_f32_32x32x16_bf16 v[16:31], a[212:215], a[132:135], v[16:31]
    buffer_load_dwordx4 a[196:199], v254, s[56:59], s37 offen offset:1024 sc1
    ds_write_addtid_b32 v6 offset:1536
    ds_write_addtid_b32 v7 offset:1792
    v_mfma_f32_32x32x16_bf16 v[16:31], a[216:219], a[140:143], v[16:31]
    ds_write_addtid_b32 v8 offset:2048
    ds_write_addtid_b32 v9 offset:2304
    ds_write_addtid_b32 v10 offset:2560
    ds_write_addtid_b32 v11 offset:2816
    v_mfma_f32_32x32x16_bf16 v[16:31], a[220:223], a[148:151], v[16:31]
    s_add_u32 s37, s25, 20480
    buffer_load_dwordx4 a[200:203], v254, s[56:59], s37 offen offset:0 sc1
    ds_write_addtid_b32 v12 offset:3072
    s_waitcnt vmcnt(16)
    v_mfma_f32_32x32x16_bf16 v[32:47], a[224:227], a[104:107], v[32:47]
    buffer_load_dwordx4 a[204:207], v254, s[56:59], s37 offen offset:1024 sc1
    ds_write_addtid_b32 v13 offset:3328
    ds_write_addtid_b32 v14 offset:3584
    s_waitcnt vmcnt(16)
    v_mfma_f32_32x32x16_bf16 v[32:47], a[228:231], a[112:115], v[32:47]
    ds_write_addtid_b32 v15 offset:3840
    s_nop 0
    ds_write_addtid_b32 v16 offset:4096
    ds_write_addtid_b32 v17 offset:4352
    s_waitcnt vmcnt(15)
    v_mfma_f32_32x32x16_bf16 v[32:47], a[232:235], a[120:123], v[32:47]
    s_add_u32 s37, s25, 32768
    buffer_load_dwordx4 a[208:211], v254, s[56:59], s37 offen offset:0 sc1
    ds_write_addtid_b32 v18 offset:4608
    s_nop 0
    s_waitcnt vmcnt(15)
    v_mfma_f32_32x32x16_bf16 v[32:47], a[236:239], a[128:131], v[32:47]
    buffer_load_dwordx4 a[212:215], v254, s[56:59], s37 offen offset:1024 sc1
    ds_write_addtid_b32 v19 offset:4864
    ds_write_addtid_b32 v20 offset:5120
    s_waitcnt vmcnt(15)
    v_mfma_f32_32x32x16_bf16 v[32:47], a[152:155], a[136:139], v[32:47]
    ds_write_addtid_b32 v21 offset:5376
    ds_write_addtid_b32 v22 offset:5632
    ds_write_addtid_b32 v23 offset:5888
    s_waitcnt vmcnt(14)
    v_mfma_f32_32x32x16_bf16 v[32:47], a[156:159], a[144:147], v[32:47]
    buffer_load_dwordx4 a[216:219], v254, s[56:59], s36 offen offset:0 sc1
    ds_write_addtid_b32 v24 offset:6144
    ds_write_addtid_b32 v25 offset:6400
    v_mfma_f32_32x32x16_bf16 v[48:63], a[224:227], a[108:111], v[48:63]
    ds_write_addtid_b32 v26 offset:6656
    ds_write_addtid_b32 v27 offset:6912
    ds_write_addtid_b32 v28 offset:7168
    ds_write_addtid_b32 v29 offset:7424
    v_mfma_f32_32x32x16_bf16 v[48:63], a[228:231], a[116:119], v[48:63]
    buffer_load_dwordx4 a[220:223], v254, s[56:59], s36 offen offset:1024 sc1
    ds_write_addtid_b32 v30 offset:7680
    ds_write_addtid_b32 v31 offset:7936
    v_mfma_f32_32x32x16_bf16 v[48:63], a[232:235], a[124:127], v[48:63]
    buffer_load_dwordx4 a[224:227], v254, s[56:59], s36 offen offset:2048 sc1
    ds_write_addtid_b32 v32 offset:8192
    ds_write_addtid_b32 v33 offset:8448
    v_mfma_f32_32x32x16_bf16 v[48:63], a[236:239], a[132:135], v[48:63]
    ds_write_addtid_b32 v34 offset:8704
    ds_write_addtid_b32 v35 offset:8960
    ds_write_addtid_b32 v36 offset:9216
    ds_write_addtid_b32 v37 offset:9472
    v_mfma_f32_32x32x16_bf16 v[48:63], a[152:155], a[140:143], v[48:63]
    buffer_load_dwordx4 a[228:231], v254, s[56:59], s36 offen offset:3072 sc1
    ds_write_addtid_b32 v38 offset:9728
    ds_write_addtid_b32 v39 offset:9984
    v_mfma_f32_32x32x16_bf16 v[48:63], a[156:159], a[148:151], v[48:63]
    s_add_u32 s37, s36, 4096
    buffer_load_dwordx4 a[232:235], v254, s[56:59], s37 offen offset:0 sc1
    ds_write_addtid_b32 v40 offset:10240
    s_waitcnt vmcnt(18)
    v_mfma_f32_32x32x16_bf16 v[64:79], a[160:163], a[32:35], v[64:79]
    ds_write_addtid_b32 v41 offset:10496
    ds_write_addtid_b32 v42 offset:10752
    ds_write_addtid_b32 v43 offset:11008
    ds_write_addtid_b32 v44 offset:11264
    v_mfma_f32_32x32x16_bf16 v[80:95], a[160:163], a[36:39], v[80:95]
    buffer_load_dwordx4 a[236:239], v254, s[56:59], s37 offen offset:2048 sc1
    ds_write_addtid_b32 v45 offset:11520
    ds_write_addtid_b32 v46 offset:11776
    s_waitcnt vmcnt(18)
    v_mfma_f32_32x32x16_bf16 v[96:111], a[164:167], a[32:35], v[96:111]
    s_add_u32 s37, s36, 8192
    buffer_load_dwordx4 a[152:155], v254, s[56:59], s37 offen offset:0 sc1
    ds_write_addtid_b32 v47 offset:12032
    ds_write_addtid_b32 v48 offset:12288
    v_mfma_f32_32x32x16_bf16 v[112:127], a[164:167], a[36:39], v[112:127]
    ds_write_addtid_b32 v49 offset:12544
    ds_write_addtid_b32 v50 offset:12800
    ds_write_addtid_b32 v51 offset:13056
    s_waitcnt vmcnt(18)
    v_mfma_f32_32x32x16_bf16 v[64:79], a[168:171], a[40:43], v[64:79]
    buffer_load_dwordx4 a[156:159], v254, s[56:59], s37 offen offset:2048 sc1
    ds_write_addtid_b32 v52 offset:13312
    ds_write_addtid_b32 v53 offset:13568
    v_mfma_f32_32x32x16_bf16 v[80:95], a[168:171], a[44:47], v[80:95]
    ds_write_addtid_b32 v54 offset:13824
    ds_write_addtid_b32 v55 offset:14080
    ds_write_addtid_b32 v56 offset:14336
    s_waitcnt vmcnt(18)
    v_mfma_f32_32x32x16_bf16 v[96:111], a[172:175], a[40:43], v[96:111]
    s_add_u32 s37, s36, 12288
    buffer_load_dwordx4 a[160:163], v254, s[56:59], s37 offen offset:0 sc1
    ds_write_addtid_b32 v57 offset:14592
    ds_write_addtid_b32 v58 offset:14848
    v_mfma_f32_32x32x16_bf16 v[112:127], a[172:175], a[44:47], v[112:127]
    buffer_load_dwordx4 a[164:167], v254, s[56:59], s37 offen offset:2048 sc1
    ds_write_addtid_b32 v59 offset:15104
    ds_write_addtid_b32 v60 offset:15360
    s_waitcnt vmcnt(19)
    v_mfma_f32_32x32x16_bf16 v[64:79], a[176:179], a[48:51], v[64:79]
    ds_write_addtid_b32 v61 offset:15616
    ds_write_addtid_b32 v62 offset:15872
    ds_write_addtid_b32 v63 offset:16128
    v_mfma_f32_32x32x16_bf16 v[80:95], a[176:179], a[52:55], v[80:95]
    s_add_u32 s37, s36, 5120
    buffer_load_dwordx4 a[168:171], v254, s[56:59], s37 offen offset:0 sc1
    s_waitcnt vmcnt(19)
L_stub_3:
    s_cbranch_execz L_back
    v_mfma_f32_32x32x16_bf16 v[96:111], a[180:183], a[48:51], v[96:111]
    v_mfma_f32_32x32x16_bf16 v[112:127], a[180:183], a[52:55], v[112:127]
    buffer_load_dwordx4 a[172:175], v254, s[56:59], s37 offen offset:2048 sc1
    s_waitcnt lgkmcnt(0)
    s_barrier
L_m_bar1:
    s_waitcnt vmcnt(19)
L_m_h26:
    v_mfma_f32_32x32x16_bf16 v[64:79], a[184:187], a[56:59], v[64:79]
    s_add_u32 s37, s36, 9216
    buffer_load_dwordx4 a[176:179], v254, s[56:59], s37 offen offset:0 sc1
    ds_read_b128 v[128:131], v235 offset:0
    ds_read_b128 v[132:135], v235 offset:16384
    v_mfma_f32_32x32x16_bf16 v[80:95], a[184:187], a[60:63], v[80:95]
    ds_read_b128 v[136:139], v235 offset:32768
    ds_read_b128 v[140:143], v235 offset:49152
    ds_read_b128 v[144:147], v235 offset:2048
    s_waitcnt vmcnt(19)
    s_nop 0
    v_mfma_f32_32x32x16_bf16 v[96:111], a[188:191], a[56:59], v[96:111]
    buffer_load_dwordx4 a[180:183], v254, s[56:59], s37 offen offset:2048 sc1
    ds_read_b128 v[148:151], v235 offset:18432
    ds_read_b128 v[152:155], v235 offset:34816
    v_mfma_f32_32x32x16_bf16 v[112:127], a[188:191], a[60:63], v[112:127]
    s_add_u32 s37, s36, 13312
    buffer_load_dwordx4 a[184:187], v254, s[56:59], s37 offen offset:0 sc1
    ds_read_b128 v[156:159], v235 offset:51200
    s_waitcnt vmcnt(20)
    v_mfma_f32_32x32x16_bf16 v[64:79], a[192:195], a[64:67], v[64:79]
    s_nop 0
    ds_read_b128 v[160:163], v235 offset:8192
    ds_read_b128 v[164:167], v235 offset:24576
    ds_read_b128 v[168:171], v235 offset:40960
    ds_read_b128 v[172:175], v235 offset:57344
    v_mfma_f32_32x32x16_bf16 v[80:95], a[192:195], a[68:71], v[80:95]
    buffer_load_dwordx4 a[188:191], v254, s[56:59], s37 offen offset:2048 sc1
    ds_read_b128 v[176:179], v235 offset:10240
    ds_read_b128 v[180:183], v235 offset:26624
    s_waitcnt vmcnt(20)
    v_mfma_f32_32x32x16_bf16 v[96:111], a[196:199], a[64:67], v[96:111]
    ds_read_b128 v[184:187], v235 offset:43008
    ds_read_b128 v[188:191], v235 offset:59392
    s_waitcnt lgkmcnt(12)
    v_add_f32 v128, v128, v132
    v_add_f32 v129, v129, v133
    v_add_f32_e64 v130, v130, v134
    v_mfma_f32_32x32x16_bf16 v[112:127], a[196:199], a[68:71], v[112:127]
    v_add_f32 v131, v131, v135
    v_add_f32 v136, v136, v140
    v_add_f32 v137, v137, v141
    v_add_f32 v138, v138, v142
    v_add_f32 v139, v139, v143
    v_add_f32 v128, v128, v136
    v_add_f32 v129, v129, v137
    s_waitcnt vmcnt(19)
    v_mfma_f32_32x32x16_bf16 v[64:79], a[200:203], a[72:75], v[64:79]
    v_add_f32 v130, v130, v138
    v_add_f32 v131, v131, v139
    v_cvt_pk_f16_f32 v132, v128, v129
    v_cvt_pk_f16_f32 v133, v130, v131
    v_bfi_b32 v132, s83, v240, v132
    v_bfi_b32 v133, s83, v241, v133
    s_waitcnt lgkmcnt(8)
    v_add_f32 v144, v144, v148
    v_mfma_f32_32x32x16_bf16 v[80:95], a[200:203], a[76:79], v[80:95]
    v_add_f32 v145, v145, v149
    v_add_f32 v146, v146, v150
    v_add_f32 v147, v147, v151
    v_add_f32 v152, v152, v156
    v_add_f32 v153, v153, v157
    v_add_f32 v154, v154, v158
    v_add_f32 v155, v155, v159
    s_waitcnt vmcnt(18)
    v_mfma_f32_32x32x16_bf16 v[96:111], a[204:207], a[72:75], v[96:111]
    v_add_f32 v144, v144, v152
    v_add_f32 v145, v145, v153
    v_add_f32 v146, v146, v154
    v_add_f32 v147, v147, v155
    v_cvt_pk_f16_f32 v134, v144, v145
    v_cvt_pk_f16_f32 v135, v146, v147
    v_bfi_b32 v134, s83, v242, v134
    v_bfi_b32 v135, s83, v243, v135
    v_mfma_f32_32x32x16_bf16 v[112:127], a[204:207], a[76:79], v[112:127]
    buffer_store_dwordx4 v[132:135], v254, s[56:59], s32 offen offset:0 sc1
    s_waitcnt lgkmcnt(4)
    v_add_f32 v160, v160, v164
    v_add_f32 v161, v161, v165
    s_waitcnt vmcnt(18)
    v_mfma_f32_32x32x16_bf16 v[64:79], a[208:211], a[80:83], v[64:79]
    v_add_f32 v162, v162, v166
    v_add_f32 v163, v163, v167
    v_add_f32 v168, v168, v172
    v_add_f32 v169, v169, v173
    v_add_f32 v170, v170, v174
    v_add_f32 v171, v171, v175
    v_add_f32 v160, v160, v168
    v_add_f32 v161, v161, v169
    v_mfma_f32_32x32x16_bf16 v[80:95], a[208:211], a[84:87], v[80:95]
    v_add_f32 v162, v162, v170
    v_add_f32 v163, v163, v171
    v_cvt_pk_f16_f32 v164, v160, v161
    v_cvt_pk_f16_f32 v165, v162, v163
    v_bfi_b32 v164, s83, v240, v164
    v_bfi_b32 v165, s83, v241, v165
    s_waitcnt lgkmcnt(0)
    s_waitcnt vmcnt(17)
    v_mfma_f32_32x32x16_bf16 v[96:111], a[212:215], a[80:83], v[96:111]
    v_add_f32 v176, v176, v180
    v_add_f32 v177, v177, v181
    v_add_f32 v178, v178, v182
    v_add_f32 v179, v179, v183
    v_add_f32 v184, v184, v188
    v_add_f32 v185, v185, v189
    v_add_f32 v186, v186, v190
    v_add_f32 v187, v187, v191
    v_mfma_f32_32x32x16_bf16 v[112:127], a[212:215], a[84:87], v[112:127]
    v_add_f32 v176, v176, v184
    v_add_f32 v177, v177, v185
    v_add_f32 v178, v178, v186
    v_add_f32 v179, v179, v187
    v_cvt_pk_f16_f32 v166, v176, v177
    v_cvt_pk_f16_f32 v167, v178, v179
    v_bfi_b32 v166, s83, v242, v166
    s_waitcnt vmcnt(16)
    v_mfma_f32_32x32x16_bf16 v[64:79], a[216:219], a[88:91], v[64:79]
    s_nop 0
    v_bfi_b32 v167, s83, v243, v167
    buffer_store_dwordx4 v[164:167], v254, s[56:59], s32 offen offset:1024 sc1
    s_xor_b32 s32, s32, 0x2000
L_m_pxs:
    v_mfma_f32_32x32x16_bf16 v[80:95], a[216:219], a[92:95], v[80:95]
    s_waitcnt vmcnt(16)
    v_mfma_f32_32x32x16_bf16 v[96:111], a[220:223], a[88:91], v[96:111]
    v_mfma_f32_32x32x16_bf16 v[112:127], a[220:223], a[92:95], v[112:127]
    s_waitcnt vmcnt(15)
    v_mfma_f32_32x32x16_bf16 v[64:79], a[224:227], a[96:99], v[64:79]
    v_mfma_f32_32x32x16_bf16 v[80:95], a[224:227], a[100:103], v[80:95]
    s_waitcnt vmcnt(14)
    v_mfma_f32_32x32x16_bf16 v[96:111], a[228:231], a[96:99], v[96:111]
    v_mfma_f32_32x32x16_bf16 v[112:127], a[228:231], a[100:103], v[112:127]
    s_waitcnt vmcnt(13)
L_m_h32:
    v_mfma_f32_32x32x16_bf16 v[64:79], a[232:235], a[104:107], v[64:79]
    s_waitcnt vmcnt(12)
    v_mfma_f32_32x32x16_bf16 v[64:79], a[236:239], a[112:115], v[64:79]
    s_waitcnt vmcnt(11)
    v_mfma_f32_32x32x16_bf16 v[64:79], a[152:155], a[120:123], v[64:79]
    s_waitcnt vmcnt(10)
    v_mfma_f32_32x32x16_bf16 v[64:79], a[156:159], a[128:131], v[64:79]
    s_waitcnt vmcnt(9)
    v_mfma_f32_32x32x16_bf16 v[64:79], a[160:163], a[136:139], v[64:79]
    s_waitcnt vmcnt(8)
    v_mfma_f32_32x32x16_bf16 v[64:79], a[164:167], a[144:147], v[64:79]
    v_mfma_f32_32x32x16_bf16 v[80:95], a[232:235], a[108:111], v[80:95]
    v_mfma_f32_32x32x16_bf16 v[80:95], a[236:239], a[116:119], v[80:95]
    s_add_u32 m0, m0, 16320
    s_nop 8
    ds_write_addtid_b32 v64 offset:49216
    ds_write_addtid_b32 v65 offset:49472
    ds_write_addtid_b32 v66 offset:49728
    v_mfma_f32_32x32x16_bf16 v[80:95], a[152:155], a[124:127], v[80:95]
    ds_write_addtid_b32 v67 offset:49984
    ds_write_addtid_b32 v68 offset:50240
    ds_write_addtid_b32 v69 offset:50496
    ds_write_addtid_b32 v70 offset:50752
    v_mfma_f32_32x32x16_bf16 v[80:95], a[156:159], a[132:135], v[80:95]
    ds_write_addtid_b32 v71 offset:51008
    ds_write_addtid_b32 v72 offset:51264
    ds_write_addtid_b32 v73 offset:51520
    ds_write_addtid_b32 v74 offset:51776
    v_mfma_f32_32x32x16_bf16 v[80:95], a[160:163], a[140:143], v[80:95]
    ds_write_addtid_b32 v75 offset:52032
    ds_write_addtid_b32 v76 offset:52288
    ds_write_addtid_b32 v77 offset:52544
    ds_write_addtid_b32 v78 offset:52800
    v_mfma_f32_32x32x16_bf16 v[80:95], a[164:167], a[148:151], v[80:95]
    ds_write_addtid_b32 v79 offset:53056
    s_waitcnt vmcnt(7)
    s_nop 0
    v_mfma_f32_32x32x16_bf16 v[96:111], a[168:171], a[104:107], v[96:111]
    s_waitcnt vmcnt(6)
    v_mfma_f32_32x32x16_bf16 v[96:111], a[172:175], a[112:115], v[96:111]
    s_nop 6
    ds_write_addtid_b32 v80 offset:53312
    ds_write_addtid_b32 v81 offset:53568
    ds_write_addtid_b32 v82 offset:53824
    s_waitcnt vmcnt(5)
    v_mfma_f32_32x32x16_bf16 v[96:111], a[176:179], a[120:123], v[96:111]
    ds_write_addtid_b32 v83 offset:54080
    ds_write_addtid_b32 v84 offset:54336
    ds_write_addtid_b32 v85 offset:54592
    s_waitcnt vmcnt(4)
    v_mfma_f32_32x32x16_bf16 v[96:111], a[180:183], a[128:131], v[96:111]
    ds_write_addtid_b32 v86 offset:54848
    ds_write_addtid_b32 v87 offset:55104
    ds_write_addtid_b32 v88 offset:55360
    s_waitcnt vmcnt(3)
    v_mfma_f32_32x32x16_bf16 v[96:111], a[184:187], a[136:139], v[96:111]
    ds_write_addtid_b32 v89 offset:55616
    ds_write_addtid_b32 v90 offset:55872
    ds_write_addtid_b32 v91 offset:56128
    s_waitcnt vmcnt(2)
    v_mfma_f32_32x32x16_bf16 v[96:111], a[188:191], a[144:147], v[96:111]
    ds_write_addtid_b32 v92 offset:56384
    ds_write_addtid_b32 v93 offset:56640
    ds_write_addtid_b32 v94 offset:56896
    ds_write_addtid_b32 v95 offset:57152
    v_mfma_f32_32x32x16_bf16 v[112:127], a[168:171], a[108:111], v[112:127]
    s_nop 0
    v_mfma_f32_32x32x16_bf16 v[112:127], a[172:175], a[116:119], v[112:127]
    s_nop 5
    ds_write_addtid_b32 v96 offset:57408
    ds_write_addtid_b32 v97 offset:57664
    ds_write_addtid_b32 v98 offset:57920
    ds_write_addtid_b32 v99 offset:58176
    s_cmp_lg_u32 s11, 3
    s_cbranch_scc1 L_nal_19
    v_lshlrev_b32_e64 v8, 7, v255
    s_mov_b32 s86, 0x8000
    buffer_load_dword v0, v8, s[56:59], s86 offen offset:12 sc1
    s_mov_b32 s86, 0xa000
    buffer_load_dword v1, v8, s[56:59], s86 offen offset:12 sc1
    s_mov_b32 s86, 0xc000
    buffer_load_dword v2, v8, s[56:59], s86 offen offset:12 sc1
    s_mov_b32 s86, 0xe000
    buffer_load_dword v3, v8, s[56:59], s86 offen offset:12 sc1
L_nal_19:
    v_mfma_f32_32x32x16_bf16 v[112:127], a[176:179], a[124:127], v[112:127]
    ds_write_addtid_b32 v100 offset:58432
    ds_write_addtid_b32 v101 offset:58688
    ds_write_addtid_b32 v102 offset:58944
    ds_write_addtid_b32 v103 offset:59200
    v_mfma_f32_32x32x16_bf16 v[112:127], a[180:183], a[132:135], v[112:127]
    ds_write_addtid_b32 v104 offset:59456
    ds_write_addtid_b32 v105 offset:59712
    ds_write_addtid_b32 v106 offset:59968
    ds_write_addtid_b32 v107 offset:60224
    v_mfma_f32_32x32x16_bf16 v[112:127], a[184:187], a[140:143], v[112:127]
    ds_write_addtid_b32 v108 offset:60480
    ds_write_addtid_b32 v109 offset:60736
    ds_write_addtid_b32 v110 offset:60992
    ds_write_addtid_b32 v111 offset:61248
    v_mfma_f32_32x32x16_bf16 v[112:127], a[188:191], a[148:151], v[112:127]
L_m_mfma2:
    s_nop 0
    s_nop 11
    ds_write_addtid_b32 v112 offset:61504
    ds_write_addtid_b32 v113 offset:61760
    ds_write_addtid_b32 v114 offset:62016
    ds_write_addtid_b32 v115 offset:62272
    ds_write_addtid_b32 v116 offset:62528
    ds_write_addtid_b32 v117 offset:62784
    ds_write_addtid_b32 v118 offset:63040
    ds_write_addtid_b32 v119 offset:63296
    ds_write_addtid_b32 v120 offset:63552
    ds_write_addtid_b32 v121 offset:63808
    ds_write_addtid_b32 v122 offset:64064
    ds_write_addtid_b32 v123 offset:64320
    ds_write_addtid_b32 v124 offset:64576
    ds_write_addtid_b32 v125 offset:64832
    ds_write_addtid_b32 v126 offset:65088
    ds_write_addtid_b32 v127 offset:65344
    s_waitcnt lgkmcnt(0)
    s_barrier
L_m_bar2:
    buffer_load_dwordx4 v[208:211], v254, s[56:59], s32 offen offset:0 sc1
    buffer_load_dwordx4 v[212:215], v254, s[56:59], s32 offen offset:1024 sc1
    ds_read_b128 v[128:131], v233 offset:0
    ds_read_b128 v[132:135], v233 offset:16384
    ds_read_b128 v[136:139], v233 offset:32768
    ds_read_b128 v[140:143], v233 offset:49152
    ds_read_b128 v[144:147], v233 offset:2048
    ds_read_b128 v[148:151], v233 offset:18432
    ds_read_b128 v[152:155], v233 offset:34816
    ds_read_b128 v[156:159], v233 offset:51200
    ds_read_b128 v[160:163], v233 offset:8192
    ds_read_b128 v[164:167], v233 offset:24576
    ds_read_b128 v[168:171], v233 offset:40960
    ds_read_b128 v[172:175], v233 offset:57344
    ds_read_b128 v[176:179], v233 offset:10240
    ds_read_b128 v[180:183], v233 offset:26624
    ds_read_b128 v[184:187], v233 offset:43008
    ds_read_b128 v[188:191], v233 offset:59392
    s_waitcnt lgkmcnt(12)
    v_pk_add_f32 v[128:129], v[128:129], v[132:133]
    v_pk_add_f32 v[136:137], v[136:137], v[140:141]
    v_pk_add_f32 v[130:131], v[130:131], v[134:135]
    v_pk_add_f32 v[138:139], v[138:139], v[142:143]
    v_pk_add_f32 v[192:193], v[192:193], v[128:129]
    v_pk_add_f32 v[194:195], v[194:195], v[130:131]
    v_pk_add_f32 v[192:193], v[192:193], v[136:137]
    v_pk_add_f32 v[194:195], v[194:195], v[138:139]
    s_waitcnt lgkmcnt(8)
    v_pk_add_f32 v[144:145], v[144:145], v[148:149]
    v_pk_add_f32 v[152:153], v[152:153], v[156:157]
    v_pk_add_f32 v[146:147], v[146:147], v[150:151]
    v_pk_add_f32 v[154:155], v[154:155], v[158:159]
    v_pk_add_f32 v[196:197], v[196:197], v[144:145]
    v_pk_add_f32 v[198:199], v[198:199], v[146:147]
    v_pk_add_f32 v[196:197], v[196:197], v[152:153]
    v_pk_add_f32 v[198:199], v[198:199], v[154:155]
    s_waitcnt lgkmcnt(4)
    v_pk_add_f32 v[160:161], v[160:161], v[164:165]
    v_pk_add_f32 v[168:169], v[168:169], v[172:173]
    v_pk_add_f32 v[162:163], v[162:163], v[166:167]
    v_pk_add_f32 v[170:171], v[170:171], v[174:175]
    v_pk_add_f32 v[200:201], v[200:201], v[160:161]
    v_pk_add_f32 v[202:203], v[202:203], v[162:163]
    v_pk_add_f32 v[200:201], v[200:201], v[168:169]
    v_pk_add_f32 v[202:203], v[202:203], v[170:171]
    s_waitcnt lgkmcnt(0)
    v_pk_add_f32 v[176:177], v[176:177], v[180:181]
    v_pk_add_f32 v[184:185], v[184:185], v[188:189]
    v_pk_add_f32 v[178:179], v[178:179], v[182:183]
    v_pk_add_f32 v[186:187], v[186:187], v[190:191]
    v_pk_add_f32 v[204:205], v[204:205], v[176:177]
    v_pk_add_f32 v[206:207], v[206:207], v[178:179]
    v_pk_add_f32 v[204:205], v[204:205], v[184:185]
    v_pk_add_f32 v[206:207], v[206:207], v[186:187]
    s_waitcnt vmcnt(0)
L_m_px1:
    v_xor_b32 v208, v240, v208
    v_xor_b32 v209, v241, v209
    v_xor_b32 v210, v242, v210
    v_xor_b32 v211, v243, v211
    v_xor_b32 v212, v240, v212
    v_xor_b32 v213, v241, v213
    v_xor_b32 v214, v242, v214
    v_xor_b32_e64 v215, v243, v215
    v_or3_b32 v224, v208, v209, v210
    v_or3_b32 v225, v211, v212, v213
    v_or3_b32 v224, v224, v214, v215
    v_or_b32_e64 v224, v224, v225
    v_and_b32 v224, s83, v224
    v_cmp_ne_u32 vcc, 0, v224
    s_cbranch_vccz L_pxd_21
    s_mov_b32 s51, 0
L_pxl_20:
    buffer_load_dwordx4 v[208:211], v254, s[56:59], s32 offen offset:0 sc1
    buffer_load_dwordx4 v[212:215], v254, s[56:59], s32 offen offset:1024 sc1
    s_waitcnt vmcnt(0)
    v_xor_b32 v208, v240, v208
    v_xor_b32 v209, v241, v209
    v_xor_b32 v210, v242, v210
    v_xor_b32 v211, v243, v211
    v_xor_b32 v212, v240, v212
    v_xor_b32 v213, v241, v213
    v_xor_b32 v214, v242, v214
    v_xor_b32_e64 v215, v243, v215
    v_or3_b32 v224, v208, v209, v210
    v_or3_b32 v225, v211, v212, v213
    v_or3_b32 v224, v224, v214, v215
    v_or_b32 v224, v224, v225
    v_and_b32 v224, s83, v224
    v_cmp_ne_u32 vcc, 0, v224
    s_add_u32 s51, s51, 1
    s_cbranch_vccz L_pxd_21
    s_cmp_le_u32 s51, 0x20000
    s_cbranch_scc1 L_pxl_20
L_pxd_21:
L_m_pxok:
    v_fma_mix_f32 v192, v208, 1.0, v192 op_sel:[0,0,0] op_sel_hi:[1,0,0]
    v_fma_mix_f32 v193, v208, 1.0, v193 op_sel:[1,0,0] op_sel_hi:[1,0,0]
    v_fma_mix_f32 v194, v209, 1.0, v194 op_sel:[0,0,0] op_sel_hi:[1,0,0]
    v_fma_mix_f32 v195, v209, 1.0, v195 op_sel:[1,0,0] op_sel_hi:[1,0,0]
    buffer_store_dwordx4 v[192:195], v239, s[72:75], 0 offen offset:0
    v_fma_mix_f32 v196, v210, 1.0, v196 op_sel:[0,0,0] op_sel_hi:[1,0,0]
    v_fma_mix_f32 v197, v210, 1.0, v197 op_sel:[1,0,0] op_sel_hi:[1,0,0]
    v_fma_mix_f32 v198, v211, 1.0, v198 op_sel:[0,0,0] op_sel_hi:[1,0,0]
    v_fma_mix_f32 v199, v211, 1.0, v199 op_sel:[1,0,0] op_sel_hi:[1,0,0]
    buffer_store_dwordx4 v[196:199], v239, s[72:75], 0 offen offset:2048
    v_fma_mix_f32 v200, v212, 1.0, v200 op_sel:[0,0,0] op_sel_hi:[1,0,0]
    v_fma_mix_f32 v201, v212, 1.0, v201 op_sel:[1,0,0] op_sel_hi:[1,0,0]
    v_fma_mix_f32 v202, v213, 1.0, v202 op_sel:[0,0,0] op_sel_hi:[1,0,0]
    v_fma_mix_f32 v203, v213, 1.0, v203 op_sel:[1,0,0] op_sel_hi:[1,0,0]
    s_movk_i32 s86, 4096
    buffer_store_dwordx4 v[200:203], v239, s[72:75], s86 offen offset:0
    v_fma_mix_f32 v204, v214, 1.0, v204 op_sel:[0,0,0] op_sel_hi:[1,0,0]
    v_fma_mix_f32 v205, v214, 1.0, v205 op_sel:[1,0,0] op_sel_hi:[1,0,0]
    v_fma_mix_f32 v206, v215, 1.0, v206 op_sel:[0,0,0] op_sel_hi:[1,0,0]
    v_fma_mix_f32 v207, v215, 1.0, v207 op_sel:[1,0,0] op_sel_hi:[1,0,0]
    buffer_store_dwordx4 v[204:207], v239, s[72:75], s86 offen offset:2048
    s_cmp_lg_u32 s11, 3
    s_cbranch_scc1 L_nep_22
    v_xor_b32 v4, s10, v0
    v_xor_b32_e64 v5, s10, v1
    v_xor_b32 v6, s10, v2
    v_xor_b32 v7, s10, v3
    v_or3_b32 v4, v4, v5, v6
    v_or_b32 v4, v4, v7
    v_cmp_ne_u32 vcc, 0, v4
    s_cbranch_vccz L_ald_24
    s_mov_b32 s51, 0
L_all_23:
    v_lshlrev_b32_e64 v8, 7, v255
    s_mov_b32 s86, 0x8000
    buffer_load_dword v0, v8, s[56:59], s86 offen offset:12 sc1
    s_mov_b32 s86, 0xa000
    buffer_load_dword v1, v8, s[56:59], s86 offen offset:12 sc1
    s_mov_b32 s86, 0xc000
    buffer_load_dword v2, v8, s[56:59], s86 offen offset:12 sc1
    s_mov_b32 s86, 0xe000
    buffer_load_dword v3, v8, s[56:59], s86 offen offset:12 sc1
    s_waitcnt vmcnt(0)
    v_xor_b32 v4, s10, v0
    v_xor_b32_e64 v5, s10, v1
    v_xor_b32 v6, s10, v2
    v_xor_b32 v7, s10, v3
    v_or3_b32 v4, v4, v5, v6
    v_or_b32 v4, v4, v7
    v_cmp_ne_u32 vcc, 0, v4
    s_add_u32 s51, s51, 1
    s_cbranch_vccz L_ald_24
    s_cmp_le_u32 s51, 0x20000
    s_cbranch_scc1 L_all_23
L_ald_24:
    v_mov_b32 v8, s10
    v_mov_b32 v9, 0
    s_mov_b64 exec, 1
    buffer_store_dword v8, v9, s[56:59], 0 offen sc1
    s_mov_b64 exec, -1
L_nep_22:
L_end:
    s_endpgm
.section .rodata,"a"
.p2align 6
.amdhsa_kernel parallel_sum__ssm_conv_s5__mixer_channel_mlp__prompt_kernel
  .amdhsa_next_free_vgpr 512
  .amdhsa_next_free_sgpr 102
  .amdhsa_accum_offset 256
  .amdhsa_group_segment_fixed_size 0
  .amdhsa_kernarg_size 136
  .amdhsa_user_sgpr_count 2
  .amdhsa_user_sgpr_kernarg_segment_ptr 1
  .amdhsa_system_sgpr_workgroup_id_x 1
.end_amdhsa_kernel
```
